```python
import torch

def _softmax(x, axis=-1):
    return torch.softmax(x, dim=axis)
def _gelu(x):
    return torch.nn.functional.gelu(x, approximate="tanh")
def _silu(x):
    return torch.nn.functional.silu(x)
def _sigmoid(x):
    return torch.sigmoid(x)
def _layernorm(x, axis=-1, eps=1e-5):
    m = x.mean(dim=axis, keepdim=True)
    v = x.var(dim=axis, keepdim=True, unbiased=False)
    return (x - m) / torch.sqrt(v + eps)
def _scatter_add(tgt, idx, src, axis=0):
    return tgt.clone().index_add_(axis, idx, src)
def _segment_sum(src, seg, n):
    out = torch.zeros((n,) + src.shape[1:], dtype=src.dtype)
    return out.index_add_(0, seg, src)
def _pad(x, pw):
    flat = tuple(v for pair in reversed(pw) for v in pair)
    return torch.nn.functional.pad(x, flat)

kernel_name = 'parallel_sum__ssm_conv_s4d__mixer_token_mlp__prompt'

def setup_inputs():

    _w = (lambda a: (lambda t: t.to(torch.bfloat16) if t.is_floating_point() else t)(torch.as_tensor(a)))
    def _A_setup():
        Bsz, L, D, N = 1, 2048, 512, 128
        return {
            "u": _w((lambda *s: torch.randn(*s, dtype=torch.bfloat16) * 0.05)(Bsz, L, D)),
            "log_A_real": _w((lambda *s: torch.randn(*s, dtype=torch.bfloat16) * 3.2)(D, N) * 0.5),
            "A_imag": _w((lambda *s: torch.randn(*s, dtype=torch.bfloat16) * 0.05)(D, N) * 3.14),
            "C_real": _w((lambda *s: torch.randn(*s, dtype=torch.bfloat16) * 0.2)(D, N) / N ** 0.5),
            "C_imag": _w((lambda *s: torch.randn(*s, dtype=torch.bfloat16) * 0.4)(D, N) / N ** 0.5),
            "log_dt": _w((lambda *s: torch.randn(*s, dtype=torch.bfloat16) * 0.05)(D) * 0.5 - 4.0),
            "D_skip": _w((lambda *s: torch.randn(*s, dtype=torch.bfloat16) * 0.05)(D)),
        }
    _A_in = _A_setup()

    def _B_setup():
        B, S, D, F = 1, 2048, 512, 1792
        return {
            "x": _w((lambda *s: torch.randn(*s, dtype=torch.bfloat16) * 0.05)(B, S, D)),
            "w1": _w((lambda *s: torch.randn(*s, dtype=torch.bfloat16) * 0.8)(S, F) * (S ** -0.5)),
            "b1": _w((lambda *s: torch.randn(*s, dtype=torch.bfloat16) * 3.2)(F) * 0.02),
            "w2": _w((lambda *s: torch.randn(*s, dtype=torch.bfloat16) * 0.8)(F, S) * (F ** -0.5)),
            "b2": _w((lambda *s: torch.randn(*s, dtype=torch.bfloat16) * 3.2)(S) * 0.02),
        }
    _B_in = _B_setup()

    return {
        "A_u": _A_in["u"],
        "A_log_A_real": _A_in["log_A_real"],
        "A_A_imag": _A_in["A_imag"],
        "A_C_real": _A_in["C_real"],
        "A_C_imag": _A_in["C_imag"],
        "A_log_dt": _A_in["log_dt"],
        "A_D_skip": _A_in["D_skip"],
        "B_x": _B_in["x"],
        "B_w1": _B_in["w1"],
        "B_b1": _B_in["b1"],
        "B_w2": _B_in["w2"],
        "B_b2": _B_in["b2"],
    }

def reference(A_u, A_log_A_real, A_A_imag, A_C_real, A_C_imag, A_log_dt, A_D_skip, B_x, B_w1, B_b1, B_w2, B_b2):
    def _A_ref(u, log_A_real, A_imag, C_real, C_imag, log_dt, D_skip):
        L = u.shape[1]
        dt = torch.exp(log_dt)
        A = -torch.exp(log_A_real) + 1j * A_imag
        C = (C_real + 1j * C_imag) * dt[:, None]
        pos = (lambda x, dt: x.to(dt))(torch.arange(L), log_dt.dtype)
        P = torch.exp((A * dt[:, None])[:, :, None] * pos[None, None, :])
        K = 2.0 * torch.einsum("dn,dnl->dl", C, P).real
        L2 = 2 * L
        u_t = (lambda x, *d: x.permute(*d))(u, 0, 2, 1)
        Kf = (lambda x, *a, **k: torch.fft.rfft(x.float(), *a, **k))(K, L2)
        Uf = (lambda x, *a, **k: torch.fft.rfft(x.float(), *a, **k))(u_t, L2)
        y = (lambda x, *a, **k: torch.fft.irfft(x, *a, **k).to(torch.bfloat16))(Uf * Kf[None, :, :], L2)[:, :, :L]
        y = (lambda x, *d: x.permute(*d))(y, 0, 2, 1)
        return y + u * D_skip[None, None, :]

    def _B_ref(x, w1, b1, w2, b2):
        B, S, D = x.shape
        h = _layernorm(x, axis=-1)
        u = torch.einsum("bsd,sf->bdf", h, w1) + b1
        u = _gelu(u)
        y = torch.einsum("bdf,fs->bds", u, w2) + b2
        return (lambda x, *d: x.permute(*d))(y, 0, 2, 1)

    x = A_u
    xn = _layernorm(x, axis=-1)
    return x + _A_ref(xn, A_log_A_real, A_A_imag, A_C_real, A_C_imag, A_log_dt, A_D_skip) + _B_ref(xn, B_w1, B_b1, B_w2, B_b2)
```

```asm
; @launch kernel=k1_prep_kernel grid=(768,1,1) block=(256,1,1) lds=16384
; @launch kernel=k2_mid_kernel grid=(512,1,1) block=(256,1,1) lds=81920
; @launch kernel=k3_out_kernel grid=(256,1,1) block=(256,1,1) lds=81920
.amdgcn_target "amdgcn-amd-amdhsa--gfx950"
.text
.globl k1_prep_kernel
.p2align 8
.type k1_prep_kernel,@function
k1_prep_kernel:
    s_cmp_ge_u32 s2, 768
    s_cbranch_scc1 K1_END
    s_cmp_ge_u32 s2, 256
    s_cbranch_scc1 K1_KGEN
    s_load_dwordx2 s[4:5], s[0:1], 0
    s_load_dwordx2 s[6:7], s[0:1], 112
    v_lshlrev_b32 v1, 4, v0
    s_mul_i32 s16, s2, 8192
    s_add_u32 s17, s16, 0x1000
    s_waitcnt lgkmcnt(0)
    s_mov_b32 s8, s4
    s_mov_b32 s9, s5
    s_mov_b32 s10, 0x200000
    s_mov_b32 s11, 0x20000
    s_mov_b32 s12, s6
    s_mov_b32 s13, s7
    s_mov_b32 s14, 0xc00000
    s_mov_b32 s15, 0x20000
    buffer_load_dwordx4 v[4:7], v1, s[8:11], s16 offen
    buffer_load_dwordx4 v[8:11], v1, s[8:11], s17 offen
    s_waitcnt vmcnt(1)
    v_lshlrev_b32 v20, 16, v4
    v_and_b32 v21, 0xffff0000, v4
    v_lshlrev_b32 v22, 16, v5
    v_and_b32 v23, 0xffff0000, v5
    v_lshlrev_b32 v24, 16, v6
    v_and_b32 v25, 0xffff0000, v6
    v_lshlrev_b32 v26, 16, v7
    v_and_b32 v27, 0xffff0000, v7
    s_waitcnt vmcnt(0)
    v_lshlrev_b32 v28, 16, v8
    v_and_b32 v29, 0xffff0000, v8
    v_lshlrev_b32 v30, 16, v9
    v_and_b32 v31, 0xffff0000, v9
    v_lshlrev_b32 v32, 16, v10
    v_and_b32 v33, 0xffff0000, v10
    v_lshlrev_b32 v34, 16, v11
    v_and_b32 v35, 0xffff0000, v11
    v_add_f32 v52, v20, v21
    v_add_f32 v53, v28, v29
    v_add_f32 v52, v52, v22
    v_add_f32 v53, v53, v30
    v_add_f32 v52, v52, v23
    v_add_f32 v53, v53, v31
    v_add_f32 v52, v52, v24
    v_add_f32 v53, v53, v32
    v_add_f32 v52, v52, v25
    v_add_f32 v53, v53, v33
    v_add_f32 v52, v52, v26
    v_add_f32 v53, v53, v34
    v_add_f32 v52, v52, v27
    v_add_f32 v53, v53, v35
    s_nop 0
    v_add_f32_dpp v52, v52, v52 row_ror:8 row_mask:0xf bank_mask:0xf
    v_add_f32_dpp v53, v53, v53 row_ror:8 row_mask:0xf bank_mask:0xf
    s_nop 0
    v_add_f32_dpp v52, v52, v52 row_ror:4 row_mask:0xf bank_mask:0xf
    v_add_f32_dpp v53, v53, v53 row_ror:4 row_mask:0xf bank_mask:0xf
    s_nop 0
    v_add_f32_dpp v52, v52, v52 row_ror:2 row_mask:0xf bank_mask:0xf
    v_add_f32_dpp v53, v53, v53 row_ror:2 row_mask:0xf bank_mask:0xf
    s_nop 0
    v_add_f32_dpp v52, v52, v52 row_ror:1 row_mask:0xf bank_mask:0xf
    v_add_f32_dpp v53, v53, v53 row_ror:1 row_mask:0xf bank_mask:0xf
    v_mov_b32 v56, v52
    v_mov_b32 v57, v53
    s_nop 0
    v_permlane16_swap_b32 v52, v56
    v_permlane16_swap_b32 v53, v57
    v_add_f32 v52, v52, v56
    v_add_f32 v53, v53, v57
    v_mov_b32 v56, v52
    v_mov_b32 v57, v53
    s_nop 0
    v_permlane32_swap_b32 v52, v56
    v_permlane32_swap_b32 v53, v57
    v_add_f32 v52, v52, v56
    v_add_f32 v53, v53, v57
    v_mul_f32 v52, 0x3b000000, v52
    v_mul_f32 v53, 0x3b000000, v53
    v_sub_f32 v56, v20, v52
    v_sub_f32 v57, v28, v53
    v_mul_f32 v60, v56, v56
    v_mul_f32 v61, v57, v57
    v_sub_f32 v56, v21, v52
    v_sub_f32 v57, v29, v53
    v_fmac_f32 v60, v56, v56
    v_fmac_f32 v61, v57, v57
    v_sub_f32 v56, v22, v52
    v_sub_f32 v57, v30, v53
    v_fmac_f32 v60, v56, v56
    v_fmac_f32 v61, v57, v57
    v_sub_f32 v56, v23, v52
    v_sub_f32 v57, v31, v53
    v_fmac_f32 v60, v56, v56
    v_fmac_f32 v61, v57, v57
    v_sub_f32 v56, v24, v52
    v_sub_f32 v57, v32, v53
    v_fmac_f32 v60, v56, v56
    v_fmac_f32 v61, v57, v57
    v_sub_f32 v56, v25, v52
    v_sub_f32 v57, v33, v53
    v_fmac_f32 v60, v56, v56
    v_fmac_f32 v61, v57, v57
    v_sub_f32 v56, v26, v52
    v_sub_f32 v57, v34, v53
    v_fmac_f32 v60, v56, v56
    v_fmac_f32 v61, v57, v57
    v_sub_f32 v56, v27, v52
    v_sub_f32 v57, v35, v53
    v_fmac_f32 v60, v56, v56
    v_fmac_f32 v61, v57, v57
    s_nop 0
    v_add_f32_dpp v60, v60, v60 row_ror:8 row_mask:0xf bank_mask:0xf
    v_add_f32_dpp v61, v61, v61 row_ror:8 row_mask:0xf bank_mask:0xf
    s_nop 0
    v_add_f32_dpp v60, v60, v60 row_ror:4 row_mask:0xf bank_mask:0xf
    v_add_f32_dpp v61, v61, v61 row_ror:4 row_mask:0xf bank_mask:0xf
    s_nop 0
    v_add_f32_dpp v60, v60, v60 row_ror:2 row_mask:0xf bank_mask:0xf
    v_add_f32_dpp v61, v61, v61 row_ror:2 row_mask:0xf bank_mask:0xf
    s_nop 0
    v_add_f32_dpp v60, v60, v60 row_ror:1 row_mask:0xf bank_mask:0xf
    v_add_f32_dpp v61, v61, v61 row_ror:1 row_mask:0xf bank_mask:0xf
    v_mov_b32 v56, v60
    v_mov_b32 v57, v61
    s_nop 0
    v_permlane16_swap_b32 v60, v56
    v_permlane16_swap_b32 v61, v57
    v_add_f32 v60, v60, v56
    v_add_f32 v61, v61, v57
    v_mov_b32 v56, v60
    v_mov_b32 v57, v61
    s_nop 0
    v_permlane32_swap_b32 v60, v56
    v_permlane32_swap_b32 v61, v57
    v_add_f32 v60, v60, v56
    v_add_f32 v61, v61, v57
    v_mul_f32 v60, 0x3b000000, v60
    v_mul_f32 v61, 0x3b000000, v61
    v_cvt_pk_bf16_f32 v56, v52, v60
    v_cvt_pk_bf16_f32 v57, v53, v61
    v_lshlrev_b32 v52, 16, v56
    v_lshlrev_b32 v53, 16, v57
    v_and_b32 v60, 0xffff0000, v56
    v_and_b32 v61, 0xffff0000, v57
    v_add_f32 v60, 0x3727c5ac, v60
    v_add_f32 v61, 0x3727c5ac, v61
    v_cvt_pk_bf16_f32 v60, v60, v60
    v_cvt_pk_bf16_f32 v61, v61, v61
    v_lshlrev_b32 v60, 16, v60
    v_lshlrev_b32 v61, 16, v61
    v_sqrt_f32 v56, v60
    v_sqrt_f32 v57, v61
    v_rsq_f32 v64, v60
    v_rsq_f32 v65, v61
    v_fma_f32 v60, -v56, v56, v60
    v_fma_f32 v61, -v57, v57, v61
    v_mul_f32 v64, 0.5, v64
    v_mul_f32 v65, 0.5, v65
    v_fmac_f32 v56, v60, v64
    v_fmac_f32 v57, v61, v65
    v_cvt_pk_bf16_f32 v56, v56, v56
    v_cvt_pk_bf16_f32 v57, v57, v57
    v_lshlrev_b32 v56, 16, v56
    v_lshlrev_b32 v57, 16, v57
    v_rcp_f32 v60, v56
    v_rcp_f32 v61, v57
    v_sub_f32 v20, v20, v52
    v_sub_f32 v28, v28, v53
    v_sub_f32 v21, v21, v52
    v_sub_f32 v29, v29, v53
    v_cvt_pk_bf16_f32 v64, v20, v21
    v_cvt_pk_bf16_f32 v65, v28, v29
    v_lshlrev_b32 v20, 16, v64
    v_lshlrev_b32 v28, 16, v65
    v_and_b32 v21, 0xffff0000, v64
    v_and_b32 v29, 0xffff0000, v65
    v_mul_f32 v64, v20, v60
    v_mul_f32 v65, v28, v61
    v_fma_f32 v20, -v64, v56, v20
    v_fma_f32 v28, -v65, v57, v28
    v_fmac_f32 v64, v20, v60
    v_fmac_f32 v65, v28, v61
    v_mul_f32 v20, v21, v60
    v_mul_f32 v28, v29, v61
    v_fma_f32 v21, -v20, v56, v21
    v_fma_f32 v29, -v28, v57, v29
    v_fmac_f32 v20, v21, v60
    v_fmac_f32 v28, v29, v61
    v_cvt_pk_bf16_f32 v4, v64, v20
    v_cvt_pk_bf16_f32 v8, v65, v28
    v_lshlrev_b32 v20, 16, v4
    v_lshlrev_b32 v28, 16, v8
    v_and_b32 v21, 0xffff0000, v4
    v_and_b32 v29, 0xffff0000, v8
    v_sub_f32 v22, v22, v52
    v_sub_f32 v30, v30, v53
    v_sub_f32 v23, v23, v52
    v_sub_f32 v31, v31, v53
    v_cvt_pk_bf16_f32 v64, v22, v23
    v_cvt_pk_bf16_f32 v65, v30, v31
    v_lshlrev_b32 v22, 16, v64
    v_lshlrev_b32 v30, 16, v65
    v_and_b32 v23, 0xffff0000, v64
    v_and_b32 v31, 0xffff0000, v65
    v_mul_f32 v64, v22, v60
    v_mul_f32 v65, v30, v61
    v_fma_f32 v22, -v64, v56, v22
    v_fma_f32 v30, -v65, v57, v30
    v_fmac_f32 v64, v22, v60
    v_fmac_f32 v65, v30, v61
    v_mul_f32 v22, v23, v60
    v_mul_f32 v30, v31, v61
    v_fma_f32 v23, -v22, v56, v23
    v_fma_f32 v31, -v30, v57, v31
    v_fmac_f32 v22, v23, v60
    v_fmac_f32 v30, v31, v61
    v_cvt_pk_bf16_f32 v5, v64, v22
    v_cvt_pk_bf16_f32 v9, v65, v30
    v_lshlrev_b32 v22, 16, v5
    v_lshlrev_b32 v30, 16, v9
    v_and_b32 v23, 0xffff0000, v5
    v_and_b32 v31, 0xffff0000, v9
    v_sub_f32 v24, v24, v52
    v_sub_f32 v32, v32, v53
    v_sub_f32 v25, v25, v52
    v_sub_f32 v33, v33, v53
    v_cvt_pk_bf16_f32 v64, v24, v25
    v_cvt_pk_bf16_f32 v65, v32, v33
    v_lshlrev_b32 v24, 16, v64
    v_lshlrev_b32 v32, 16, v65
    v_and_b32 v25, 0xffff0000, v64
    v_and_b32 v33, 0xffff0000, v65
    v_mul_f32 v64, v24, v60
    v_mul_f32 v65, v32, v61
    v_fma_f32 v24, -v64, v56, v24
    v_fma_f32 v32, -v65, v57, v32
    v_fmac_f32 v64, v24, v60
    v_fmac_f32 v65, v32, v61
    v_mul_f32 v24, v25, v60
    v_mul_f32 v32, v33, v61
    v_fma_f32 v25, -v24, v56, v25
    v_fma_f32 v33, -v32, v57, v33
    v_fmac_f32 v24, v25, v60
    v_fmac_f32 v32, v33, v61
    v_cvt_pk_bf16_f32 v6, v64, v24
    v_cvt_pk_bf16_f32 v10, v65, v32
    v_lshlrev_b32 v24, 16, v6
    v_lshlrev_b32 v32, 16, v10
    v_and_b32 v25, 0xffff0000, v6
    v_and_b32 v33, 0xffff0000, v10
    v_sub_f32 v26, v26, v52
    v_sub_f32 v34, v34, v53
    v_sub_f32 v27, v27, v52
    v_sub_f32 v35, v35, v53
    v_cvt_pk_bf16_f32 v64, v26, v27
    v_cvt_pk_bf16_f32 v65, v34, v35
    v_lshlrev_b32 v26, 16, v64
    v_lshlrev_b32 v34, 16, v65
    v_and_b32 v27, 0xffff0000, v64
    v_and_b32 v35, 0xffff0000, v65
    v_mul_f32 v64, v26, v60
    v_mul_f32 v65, v34, v61
    v_fma_f32 v26, -v64, v56, v26
    v_fma_f32 v34, -v65, v57, v34
    v_fmac_f32 v64, v26, v60
    v_fmac_f32 v65, v34, v61
    v_mul_f32 v26, v27, v60
    v_mul_f32 v34, v35, v61
    v_fma_f32 v27, -v26, v56, v27
    v_fma_f32 v35, -v34, v57, v35
    v_fmac_f32 v26, v27, v60
    v_fmac_f32 v34, v35, v61
    v_cvt_pk_bf16_f32 v7, v64, v26
    v_cvt_pk_bf16_f32 v11, v65, v34
    v_lshlrev_b32 v26, 16, v7
    v_lshlrev_b32 v34, 16, v11
    v_and_b32 v27, 0xffff0000, v7
    v_and_b32 v35, 0xffff0000, v11
    buffer_store_dwordx4 v[4:7], v1, s[12:15], s16 offen
    buffer_store_dwordx4 v[8:11], v1, s[12:15], s17 offen
    v_cvt_pkrtz_f16_f32 v68, v20, v21
    v_cvt_pkrtz_f16_f32 v69, v22, v23
    v_cvt_pkrtz_f16_f32 v70, v24, v25
    v_cvt_pkrtz_f16_f32 v71, v26, v27
    v_cvt_pkrtz_f16_f32 v72, v28, v29
    v_cvt_pkrtz_f16_f32 v73, v30, v31
    v_cvt_pkrtz_f16_f32 v74, v32, v33
    v_cvt_pkrtz_f16_f32 v75, v34, v35
    ds_write_b128 v1, v[68:71] offset:0
    ds_write_b128 v1, v[72:75] offset:4096
    v_add_f32 v52, v20, v21
    v_add_f32 v53, v28, v29
    v_add_f32 v52, v52, v22
    v_add_f32 v53, v53, v30
    v_add_f32 v52, v52, v23
    v_add_f32 v53, v53, v31
    v_add_f32 v52, v52, v24
    v_add_f32 v53, v53, v32
    v_add_f32 v52, v52, v25
    v_add_f32 v53, v53, v33
    v_add_f32 v52, v52, v26
    v_add_f32 v53, v53, v34
    v_add_f32 v52, v52, v27
    v_add_f32 v53, v53, v35
    s_nop 0
    v_add_f32_dpp v52, v52, v52 row_ror:8 row_mask:0xf bank_mask:0xf
    v_add_f32_dpp v53, v53, v53 row_ror:8 row_mask:0xf bank_mask:0xf
    s_nop 0
    v_add_f32_dpp v52, v52, v52 row_ror:4 row_mask:0xf bank_mask:0xf
    v_add_f32_dpp v53, v53, v53 row_ror:4 row_mask:0xf bank_mask:0xf
    s_nop 0
    v_add_f32_dpp v52, v52, v52 row_ror:2 row_mask:0xf bank_mask:0xf
    v_add_f32_dpp v53, v53, v53 row_ror:2 row_mask:0xf bank_mask:0xf
    s_nop 0
    v_add_f32_dpp v52, v52, v52 row_ror:1 row_mask:0xf bank_mask:0xf
    v_add_f32_dpp v53, v53, v53 row_ror:1 row_mask:0xf bank_mask:0xf
    v_mov_b32 v56, v52
    v_mov_b32 v57, v53
    s_nop 0
    v_permlane16_swap_b32 v52, v56
    v_permlane16_swap_b32 v53, v57
    v_add_f32 v52, v52, v56
    v_add_f32 v53, v53, v57
    v_mov_b32 v56, v52
    v_mov_b32 v57, v53
    s_nop 0
    v_permlane32_swap_b32 v52, v56
    v_permlane32_swap_b32 v53, v57
    v_add_f32 v52, v52, v56
    v_add_f32 v53, v53, v57
    v_mul_f32 v52, 0x3b000000, v52
    v_mul_f32 v53, 0x3b000000, v53
    v_sub_f32 v56, v20, v52
    v_sub_f32 v57, v28, v53
    v_mul_f32 v60, v56, v56
    v_mul_f32 v61, v57, v57
    v_sub_f32 v56, v21, v52
    v_sub_f32 v57, v29, v53
    v_fmac_f32 v60, v56, v56
    v_fmac_f32 v61, v57, v57
    v_sub_f32 v56, v22, v52
    v_sub_f32 v57, v30, v53
    v_fmac_f32 v60, v56, v56
    v_fmac_f32 v61, v57, v57
    v_sub_f32 v56, v23, v52
    v_sub_f32 v57, v31, v53
    v_fmac_f32 v60, v56, v56
    v_fmac_f32 v61, v57, v57
    v_sub_f32 v56, v24, v52
    v_sub_f32 v57, v32, v53
    v_fmac_f32 v60, v56, v56
    v_fmac_f32 v61, v57, v57
    v_sub_f32 v56, v25, v52
    v_sub_f32 v57, v33, v53
    v_fmac_f32 v60, v56, v56
    v_fmac_f32 v61, v57, v57
    v_sub_f32 v56, v26, v52
    v_sub_f32 v57, v34, v53
    v_fmac_f32 v60, v56, v56
    v_fmac_f32 v61, v57, v57
    v_sub_f32 v56, v27, v52
    v_sub_f32 v57, v35, v53
    v_fmac_f32 v60, v56, v56
    v_fmac_f32 v61, v57, v57
    s_nop 0
    v_add_f32_dpp v60, v60, v60 row_ror:8 row_mask:0xf bank_mask:0xf
    v_add_f32_dpp v61, v61, v61 row_ror:8 row_mask:0xf bank_mask:0xf
    s_nop 0
    v_add_f32_dpp v60, v60, v60 row_ror:4 row_mask:0xf bank_mask:0xf
    v_add_f32_dpp v61, v61, v61 row_ror:4 row_mask:0xf bank_mask:0xf
    s_nop 0
    v_add_f32_dpp v60, v60, v60 row_ror:2 row_mask:0xf bank_mask:0xf
    v_add_f32_dpp v61, v61, v61 row_ror:2 row_mask:0xf bank_mask:0xf
    s_nop 0
    v_add_f32_dpp v60, v60, v60 row_ror:1 row_mask:0xf bank_mask:0xf
    v_add_f32_dpp v61, v61, v61 row_ror:1 row_mask:0xf bank_mask:0xf
    v_mov_b32 v56, v60
    v_mov_b32 v57, v61
    s_nop 0
    v_permlane16_swap_b32 v60, v56
    v_permlane16_swap_b32 v61, v57
    v_add_f32 v60, v60, v56
    v_add_f32 v61, v61, v57
    v_mov_b32 v56, v60
    v_mov_b32 v57, v61
    s_nop 0
    v_permlane32_swap_b32 v60, v56
    v_permlane32_swap_b32 v61, v57
    v_add_f32 v60, v60, v56
    v_add_f32 v61, v61, v57
    v_mul_f32 v60, 0x3b000000, v60
    v_mul_f32 v61, 0x3b000000, v61
    v_cvt_pk_bf16_f32 v56, v52, v60
    v_cvt_pk_bf16_f32 v57, v53, v61
    v_lshlrev_b32 v52, 16, v56
    v_lshlrev_b32 v53, 16, v57
    v_and_b32 v60, 0xffff0000, v56
    v_and_b32 v61, 0xffff0000, v57
    v_add_f32 v60, 0x3727c5ac, v60
    v_add_f32 v61, 0x3727c5ac, v61
    v_cvt_pk_bf16_f32 v60, v60, v60
    v_cvt_pk_bf16_f32 v61, v61, v61
    v_lshlrev_b32 v60, 16, v60
    v_lshlrev_b32 v61, 16, v61
    v_sqrt_f32 v56, v60
    v_sqrt_f32 v57, v61
    v_rsq_f32 v64, v60
    v_rsq_f32 v65, v61
    v_fma_f32 v60, -v56, v56, v60
    v_fma_f32 v61, -v57, v57, v61
    v_mul_f32 v64, 0.5, v64
    v_mul_f32 v65, 0.5, v65
    v_fmac_f32 v56, v60, v64
    v_fmac_f32 v57, v61, v65
    v_cvt_pk_bf16_f32 v56, v56, v56
    v_cvt_pk_bf16_f32 v57, v57, v57
    v_lshlrev_b32 v56, 16, v56
    v_lshlrev_b32 v57, 16, v57
    v_rcp_f32 v60, v56
    v_rcp_f32 v61, v57
    v_sub_f32 v20, v20, v52
    v_sub_f32 v28, v28, v53
    v_sub_f32 v21, v21, v52
    v_sub_f32 v29, v29, v53
    v_cvt_pk_bf16_f32 v64, v20, v21
    v_cvt_pk_bf16_f32 v65, v28, v29
    v_lshlrev_b32 v20, 16, v64
    v_lshlrev_b32 v28, 16, v65
    v_and_b32 v21, 0xffff0000, v64
    v_and_b32 v29, 0xffff0000, v65
    v_mul_f32 v64, v20, v60
    v_mul_f32 v65, v28, v61
    v_fma_f32 v20, -v64, v56, v20
    v_fma_f32 v28, -v65, v57, v28
    v_fmac_f32 v64, v20, v60
    v_fmac_f32 v65, v28, v61
    v_mul_f32 v20, v21, v60
    v_mul_f32 v28, v29, v61
    v_fma_f32 v21, -v20, v56, v21
    v_fma_f32 v29, -v28, v57, v29
    v_fmac_f32 v20, v21, v60
    v_fmac_f32 v28, v29, v61
    v_cvt_pk_bf16_f32 v84, v64, v20
    v_cvt_pk_bf16_f32 v88, v65, v28
    v_lshlrev_b32 v20, 16, v84
    v_lshlrev_b32 v28, 16, v88
    v_and_b32 v21, 0xffff0000, v84
    v_and_b32 v29, 0xffff0000, v88
    v_sub_f32 v22, v22, v52
    v_sub_f32 v30, v30, v53
    v_sub_f32 v23, v23, v52
    v_sub_f32 v31, v31, v53
    v_cvt_pk_bf16_f32 v64, v22, v23
    v_cvt_pk_bf16_f32 v65, v30, v31
    v_lshlrev_b32 v22, 16, v64
    v_lshlrev_b32 v30, 16, v65
    v_and_b32 v23, 0xffff0000, v64
    v_and_b32 v31, 0xffff0000, v65
    v_mul_f32 v64, v22, v60
    v_mul_f32 v65, v30, v61
    v_fma_f32 v22, -v64, v56, v22
    v_fma_f32 v30, -v65, v57, v30
    v_fmac_f32 v64, v22, v60
    v_fmac_f32 v65, v30, v61
    v_mul_f32 v22, v23, v60
    v_mul_f32 v30, v31, v61
    v_fma_f32 v23, -v22, v56, v23
    v_fma_f32 v31, -v30, v57, v31
    v_fmac_f32 v22, v23, v60
    v_fmac_f32 v30, v31, v61
    v_cvt_pk_bf16_f32 v85, v64, v22
    v_cvt_pk_bf16_f32 v89, v65, v30
    v_lshlrev_b32 v22, 16, v85
    v_lshlrev_b32 v30, 16, v89
    v_and_b32 v23, 0xffff0000, v85
    v_and_b32 v31, 0xffff0000, v89
    v_sub_f32 v24, v24, v52
    v_sub_f32 v32, v32, v53
    v_sub_f32 v25, v25, v52
    v_sub_f32 v33, v33, v53
    v_cvt_pk_bf16_f32 v64, v24, v25
    v_cvt_pk_bf16_f32 v65, v32, v33
    v_lshlrev_b32 v24, 16, v64
    v_lshlrev_b32 v32, 16, v65
    v_and_b32 v25, 0xffff0000, v64
    v_and_b32 v33, 0xffff0000, v65
    v_mul_f32 v64, v24, v60
    v_mul_f32 v65, v32, v61
    v_fma_f32 v24, -v64, v56, v24
    v_fma_f32 v32, -v65, v57, v32
    v_fmac_f32 v64, v24, v60
    v_fmac_f32 v65, v32, v61
    v_mul_f32 v24, v25, v60
    v_mul_f32 v32, v33, v61
    v_fma_f32 v25, -v24, v56, v25
    v_fma_f32 v33, -v32, v57, v33
    v_fmac_f32 v24, v25, v60
    v_fmac_f32 v32, v33, v61
    v_cvt_pk_bf16_f32 v86, v64, v24
    v_cvt_pk_bf16_f32 v90, v65, v32
    v_lshlrev_b32 v24, 16, v86
    v_lshlrev_b32 v32, 16, v90
    v_and_b32 v25, 0xffff0000, v86
    v_and_b32 v33, 0xffff0000, v90
    v_sub_f32 v26, v26, v52
    v_sub_f32 v34, v34, v53
    v_sub_f32 v27, v27, v52
    v_sub_f32 v35, v35, v53
    v_cvt_pk_bf16_f32 v64, v26, v27
    v_cvt_pk_bf16_f32 v65, v34, v35
    v_lshlrev_b32 v26, 16, v64
    v_lshlrev_b32 v34, 16, v65
    v_and_b32 v27, 0xffff0000, v64
    v_and_b32 v35, 0xffff0000, v65
    v_mul_f32 v64, v26, v60
    v_mul_f32 v65, v34, v61
    v_fma_f32 v26, -v64, v56, v26
    v_fma_f32 v34, -v65, v57, v34
    v_fmac_f32 v64, v26, v60
    v_fmac_f32 v65, v34, v61
    v_mul_f32 v26, v27, v60
    v_mul_f32 v34, v35, v61
    v_fma_f32 v27, -v26, v56, v27
    v_fma_f32 v35, -v34, v57, v35
    v_fmac_f32 v26, v27, v60
    v_fmac_f32 v34, v35, v61
    v_cvt_pk_bf16_f32 v87, v64, v26
    v_cvt_pk_bf16_f32 v91, v65, v34
    v_lshlrev_b32 v26, 16, v87
    v_lshlrev_b32 v34, 16, v91
    v_and_b32 v27, 0xffff0000, v87
    v_and_b32 v35, 0xffff0000, v91
    v_add_u32 v2, 0x200000, v1
    buffer_store_dwordx4 v[84:87], v2, s[12:15], s16 offen
    buffer_store_dwordx4 v[88:91], v2, s[12:15], s17 offen
    s_waitcnt lgkmcnt(0)
    s_barrier
    v_lshlrev_b32 v2, 2, v0
    ds_read_b32 v20, v2 offset:0
    ds_read_b32 v21, v2 offset:1024
    ds_read_b32 v22, v2 offset:2048
    ds_read_b32 v23, v2 offset:3072
    ds_read_b32 v24, v2 offset:4096
    ds_read_b32 v25, v2 offset:5120
    ds_read_b32 v26, v2 offset:6144
    ds_read_b32 v27, v2 offset:7168
    s_mov_b32 s20, 0x05040100
    s_mov_b32 s21, 0x07060302
    v_mul_u32_u24 v3, 8320, v0
    s_mul_i32 s22, s2, 16
    s_add_u32 s22, s22, 0x400040
    s_waitcnt lgkmcnt(0)
    v_perm_b32 v36, v21, v20, s20
    v_perm_b32 v44, v21, v20, s21
    v_perm_b32 v37, v23, v22, s20
    v_perm_b32 v45, v23, v22, s21
    v_perm_b32 v38, v25, v24, s20
    v_perm_b32 v46, v25, v24, s21
    v_perm_b32 v39, v27, v26, s20
    v_perm_b32 v47, v27, v26, s21
    s_add_u32 s23, s22, 4160
    buffer_store_dwordx4 v[36:39], v3, s[12:15], s22 offen offset:0
    buffer_store_dwordx4 v[44:47], v3, s[12:15], s23 offen offset:0
    s_cmp_lg_u32 s2, 0
    s_cbranch_scc1 K1_END
    v_mov_b32 v52, 0
    v_mov_b32 v53, 0
    v_mov_b32 v54, 0
    v_mov_b32 v55, 0
    s_mov_b32 s23, 0x400000
    buffer_store_dwordx4 v[52:55], v3, s[12:15], s23 offen offset:0
    buffer_store_dwordx4 v[52:55], v3, s[12:15], s23 offen offset:16
    buffer_store_dwordx4 v[52:55], v3, s[12:15], s23 offen offset:32
    buffer_store_dwordx4 v[52:55], v3, s[12:15], s23 offen offset:48
    s_mov_b32 s23, 0x401040
    buffer_store_dwordx4 v[52:55], v3, s[12:15], s23 offen offset:0
    buffer_store_dwordx4 v[52:55], v3, s[12:15], s23 offen offset:16
    buffer_store_dwordx4 v[52:55], v3, s[12:15], s23 offen offset:32
    buffer_store_dwordx4 v[52:55], v3, s[12:15], s23 offen offset:48
    s_branch K1_END
K1_KGEN:
    s_sub_u32 s3, s2, 256
    s_load_dwordx2 s[60:61], s[0:1], 8
    s_load_dwordx2 s[62:63], s[0:1], 16
    s_load_dwordx2 s[64:65], s[0:1], 24
    s_load_dwordx2 s[66:67], s[0:1], 32
    s_load_dwordx2 s[68:69], s[0:1], 40
    s_load_dwordx2 s[70:71], s[0:1], 112
    v_bfe_u32 v1, v0, 4, 4
    v_lshlrev_b32 v1, 4, v1
    s_lshl_b32 s16, s3, 8
    s_lshl_b32 s17, s3, 1
    s_mov_b32 s24, 0x3fb8aa3b
    s_mov_b32 s25, 0x32a57060
    s_mov_b32 s26, 0x3f317218
    s_mov_b32 s27, 0x3e22f983
    s_mov_b32 s28, 0xbfb8aa3b
    v_mov_b32 v2, 0
    s_waitcnt lgkmcnt(0)
    s_mov_b32 s32, s60
    s_mov_b32 s33, s61
    s_mov_b32 s34, 0x20000
    s_mov_b32 s35, 0x20000
    s_mov_b32 s36, s62
    s_mov_b32 s37, s63
    s_mov_b32 s38, 0x20000
    s_mov_b32 s39, 0x20000
    s_mov_b32 s40, s64
    s_mov_b32 s41, s65
    s_mov_b32 s42, 0x20000
    s_mov_b32 s43, 0x20000
    s_mov_b32 s44, s66
    s_mov_b32 s45, s67
    s_mov_b32 s46, 0x20000
    s_mov_b32 s47, 0x20000
    s_mov_b32 s48, s68
    s_mov_b32 s49, s69
    s_mov_b32 s50, 0x400
    s_mov_b32 s51, 0x20000
    s_mov_b32 s52, s70
    s_mov_b32 s53, s71
    s_mov_b32 s54, 0xc00000
    s_mov_b32 s55, 0x20000
    buffer_load_ushort v3, v2, s[48:51], s17 offen
    s_load_dwordx2 s[72:73], s[0:1], 64
    s_load_dwordx2 s[74:75], s[0:1], 80
    v_lshlrev_b32 v58, 6, v0
    s_mul_i32 s18, s3, 14336
    s_waitcnt lgkmcnt(0)
    s_mov_b32 s76, s72
    s_mov_b32 s77, s73
    s_mov_b32 s78, 0x700000
    s_mov_b32 s79, 0x20000
    s_mov_b32 s80, s74
    s_mov_b32 s81, s75
    s_mov_b32 s82, 0x700000
    s_mov_b32 s83, 0x20000
    buffer_load_dword v59, v58, s[76:79], s18 offen
    buffer_load_dword v60, v58, s[80:83], s18 offen
    buffer_load_dwordx4 v[4:7], v1, s[32:35], s16 offen
    buffer_load_dwordx4 v[8:11], v1, s[36:39], s16 offen
    buffer_load_dwordx4 v[12:15], v1, s[40:43], s16 offen
    buffer_load_dwordx4 v[16:19], v1, s[44:47], s16 offen
    v_and_b32 v20, 15, v0
    v_lshlrev_b32 v21, 3, v20
    v_cvt_f32_u32 v21, v21
    v_and_b32 v22, 8, v20
    v_lshlrev_b32 v22, 4, v22
    v_and_b32 v23, 7, v20
    v_or_b32 v22, v22, v23
    v_cvt_f32_u32 v22, v22
    v_and_b32 v23, 4, v20
    v_lshlrev_b32 v23, 5, v23
    v_and_b32 v24, 3, v20
    v_lshl_or_b32 v23, v24, 1, v23
    v_add_u32 v23, 0x100, v23
    v_and_b32 v24, 6, v20
    v_lshlrev_b32 v24, 6, v24
    v_and_b32 v25, 1, v20
    v_lshl_or_b32 v24, v25, 2, v24
    v_add_u32 v24, 0x200, v24
    v_cmp_gt_u32 vcc, 8, v20
    s_nop 1
    v_cndmask_b32 v23, v24, v23, vcc
    v_cvt_f32_u32 v23, v23
    v_lshlrev_b32 v24, 7, v20
    v_add_u32 v24, 0x400, v24
    v_cvt_f32_u32 v24, v24
    s_waitcnt vmcnt(6)
    v_lshlrev_b32 v3, 16, v3
    v_mul_f32 v27, s24, v3
    v_fma_f32 v28, v3, s24, -v27
    v_fmac_f32 v28, s25, v3
    v_exp_f32 v26, v27
    s_nop 0
    v_mul_f32 v28, v28, v26
    v_fmac_f32 v26, s26, v28
    v_cvt_pk_bf16_f32 v26, v26, v26
    v_lshlrev_b32 v26, 16, v26
    s_waitcnt vmcnt(0)
    v_mov_b32 v27, 0
    v_and_b32 v28, 0x7fff7fff, v12
    v_lshlrev_b32 v29, 16, v28
    v_and_b32 v28, 0xffff0000, v28
    v_add_f32 v27, v27, v29
    v_add_f32 v27, v27, v28
    v_and_b32 v28, 0x7fff7fff, v13
    v_lshlrev_b32 v29, 16, v28
    v_and_b32 v28, 0xffff0000, v28
    v_add_f32 v27, v27, v29
    v_add_f32 v27, v27, v28
    v_and_b32 v28, 0x7fff7fff, v14
    v_lshlrev_b32 v29, 16, v28
    v_and_b32 v28, 0xffff0000, v28
    v_add_f32 v27, v27, v29
    v_add_f32 v27, v27, v28
    v_and_b32 v28, 0x7fff7fff, v15
    v_lshlrev_b32 v29, 16, v28
    v_and_b32 v28, 0xffff0000, v28
    v_add_f32 v27, v27, v29
    v_add_f32 v27, v27, v28
    v_and_b32 v28, 0x7fff7fff, v16
    v_lshlrev_b32 v29, 16, v28
    v_and_b32 v28, 0xffff0000, v28
    v_add_f32 v27, v27, v29
    v_add_f32 v27, v27, v28
    v_and_b32 v28, 0x7fff7fff, v17
    v_lshlrev_b32 v29, 16, v28
    v_and_b32 v28, 0xffff0000, v28
    v_add_f32 v27, v27, v29
    v_add_f32 v27, v27, v28
    v_and_b32 v28, 0x7fff7fff, v18
    v_lshlrev_b32 v29, 16, v28
    v_and_b32 v28, 0xffff0000, v28
    v_add_f32 v27, v27, v29
    v_add_f32 v27, v27, v28
    v_and_b32 v28, 0x7fff7fff, v19
    v_lshlrev_b32 v29, 16, v28
    v_and_b32 v28, 0xffff0000, v28
    v_add_f32 v27, v27, v29
    v_add_f32 v27, v27, v28
    v_mov_b32 v28, v27
    s_nop 1
    v_permlane16_swap_b32 v27, v28
    v_add_f32 v27, v27, v28
    v_mov_b32 v28, v27
    s_nop 1
    v_permlane32_swap_b32 v27, v28
    v_add_f32 v27, v27, v28
    v_lshrrev_b32 v28, 6, v0
    v_lshlrev_b32 v28, 2, v28
    ds_write_b32 v28, v27 offset:12288
    v_lshlrev_b32 v30, 16, v4
    v_mul_f32 v32, s24, v30
    v_fma_f32 v33, v30, s24, -v32
    v_fmac_f32 v33, s25, v30
    v_exp_f32 v31, v32
    s_nop 0
    v_mul_f32 v33, v33, v31
    v_fmac_f32 v31, s26, v33
    v_cvt_pk_bf16_f32 v31, v31, v31
    v_lshlrev_b32 v31, 16, v31
    v_mul_f32 v31, v31, v26
    v_mul_f32 v31, s28, v31
    v_lshlrev_b32 v32, 16, v8
    v_mul_f32 v32, v32, v26
    v_mul_f32 v32, s27, v32
    v_lshlrev_b32 v33, 16, v12
    v_mul_f32 v33, v33, v26
    v_lshlrev_b32 v34, 16, v16
    v_mul_f32 v34, v34, v26
    v_mul_f32 v36, v31, v21
    v_mul_f32 v40, v32, v21
    v_mul_f32 v37, v31, v22
    v_mul_f32 v41, v32, v22
    v_mul_f32 v38, v31, v23
    v_mul_f32 v42, v32, v23
    v_mul_f32 v39, v31, v24
    v_mul_f32 v43, v32, v24
    v_fract_f32 v40, v40
    v_fract_f32 v41, v41
    v_fract_f32 v42, v42
    v_fract_f32 v43, v43
    v_exp_f32 v36, v36
    v_exp_f32 v37, v37
    v_exp_f32 v38, v38
    v_exp_f32 v39, v39
    v_sin_f32 v44, v40
    v_sin_f32 v45, v41
    v_sin_f32 v46, v42
    v_sin_f32 v47, v43
    v_cos_f32 v40, v40
    v_cos_f32 v41, v41
    v_cos_f32 v42, v42
    v_cos_f32 v43, v43
    v_mul_f32 v44, v44, v36
    v_mul_f32 v45, v45, v37
    v_mul_f32 v46, v46, v38
    v_mul_f32 v47, v47, v39
    v_mul_f32 v40, v40, v36
    v_mul_f32 v41, v41, v37
    v_mul_f32 v42, v42, v38
    v_mul_f32 v43, v43, v39
    v_mul_f32 v48, v33, v41
    v_mul_f32 v52, v33, v45
    v_mul_f32 v49, v33, v42
    v_mul_f32 v53, v33, v46
    v_mul_f32 v50, v33, v43
    v_mul_f32 v54, v33, v47
    v_fma_f32 v48, -v34, v45, v48
    v_fma_f32 v52, -v34, v41, -v52
    v_fma_f32 v49, -v34, v46, v49
    v_fma_f32 v53, -v34, v42, -v53
    v_fma_f32 v50, -v34, v47, v50
    v_fma_f32 v54, -v34, v43, -v54
    v_cvt_pk_bf16_f32 v100, v40, v44
    v_cvt_pk_bf16_f32 v116, v48, v52
    v_cvt_pk_bf16_f32 v124, v49, v53
    v_cvt_pk_bf16_f32 v132, v50, v54
    v_lshlrev_b32 v56, 16, v100
    v_and_b32 v57, 0xffff0000, v100
    v_sub_f32 v56, v40, v56
    v_sub_f32 v57, v44, v57
    v_cvt_pk_bf16_f32 v108, v56, v57
    v_lshlrev_b32 v56, 16, v116
    v_and_b32 v57, 0xffff0000, v116
    v_sub_f32 v56, v48, v56
    v_sub_f32 v57, v52, v57
    v_cvt_pk_bf16_f32 v140, v56, v57
    v_lshlrev_b32 v56, 16, v124
    v_and_b32 v57, 0xffff0000, v124
    v_sub_f32 v56, v49, v56
    v_sub_f32 v57, v53, v57
    v_cvt_pk_bf16_f32 v148, v56, v57
    v_lshlrev_b32 v56, 16, v132
    v_and_b32 v57, 0xffff0000, v132
    v_sub_f32 v56, v50, v56
    v_sub_f32 v57, v54, v57
    v_cvt_pk_bf16_f32 v156, v56, v57
    v_and_b32 v30, 0xffff0000, v4
    v_mul_f32 v32, s24, v30
    v_fma_f32 v33, v30, s24, -v32
    v_fmac_f32 v33, s25, v30
    v_exp_f32 v31, v32
    s_nop 0
    v_mul_f32 v33, v33, v31
    v_fmac_f32 v31, s26, v33
    v_cvt_pk_bf16_f32 v31, v31, v31
    v_lshlrev_b32 v31, 16, v31
    v_mul_f32 v31, v31, v26
    v_mul_f32 v31, s28, v31
    v_and_b32 v32, 0xffff0000, v8
    v_mul_f32 v32, v32, v26
    v_mul_f32 v32, s27, v32
    v_and_b32 v33, 0xffff0000, v12
    v_mul_f32 v33, v33, v26
    v_and_b32 v34, 0xffff0000, v16
    v_mul_f32 v34, v34, v26
    v_mul_f32 v36, v31, v21
    v_mul_f32 v40, v32, v21
    v_mul_f32 v37, v31, v22
    v_mul_f32 v41, v32, v22
    v_mul_f32 v38, v31, v23
    v_mul_f32 v42, v32, v23
    v_mul_f32 v39, v31, v24
    v_mul_f32 v43, v32, v24
    v_fract_f32 v40, v40
    v_fract_f32 v41, v41
    v_fract_f32 v42, v42
    v_fract_f32 v43, v43
    v_exp_f32 v36, v36
    v_exp_f32 v37, v37
    v_exp_f32 v38, v38
    v_exp_f32 v39, v39
    v_sin_f32 v44, v40
    v_sin_f32 v45, v41
    v_sin_f32 v46, v42
    v_sin_f32 v47, v43
    v_cos_f32 v40, v40
    v_cos_f32 v41, v41
    v_cos_f32 v42, v42
    v_cos_f32 v43, v43
    v_mul_f32 v44, v44, v36
    v_mul_f32 v45, v45, v37
    v_mul_f32 v46, v46, v38
    v_mul_f32 v47, v47, v39
    v_mul_f32 v40, v40, v36
    v_mul_f32 v41, v41, v37
    v_mul_f32 v42, v42, v38
    v_mul_f32 v43, v43, v39
    v_mul_f32 v48, v33, v41
    v_mul_f32 v52, v33, v45
    v_mul_f32 v49, v33, v42
    v_mul_f32 v53, v33, v46
    v_mul_f32 v50, v33, v43
    v_mul_f32 v54, v33, v47
    v_fma_f32 v48, -v34, v45, v48
    v_fma_f32 v52, -v34, v41, -v52
    v_fma_f32 v49, -v34, v46, v49
    v_fma_f32 v53, -v34, v42, -v53
    v_fma_f32 v50, -v34, v47, v50
    v_fma_f32 v54, -v34, v43, -v54
    v_cvt_pk_bf16_f32 v101, v40, v44
    v_cvt_pk_bf16_f32 v117, v48, v52
    v_cvt_pk_bf16_f32 v125, v49, v53
    v_cvt_pk_bf16_f32 v133, v50, v54
    v_lshlrev_b32 v56, 16, v101
    v_and_b32 v57, 0xffff0000, v101
    v_sub_f32 v56, v40, v56
    v_sub_f32 v57, v44, v57
    v_cvt_pk_bf16_f32 v109, v56, v57
    v_lshlrev_b32 v56, 16, v117
    v_and_b32 v57, 0xffff0000, v117
    v_sub_f32 v56, v48, v56
    v_sub_f32 v57, v52, v57
    v_cvt_pk_bf16_f32 v141, v56, v57
    v_lshlrev_b32 v56, 16, v125
    v_and_b32 v57, 0xffff0000, v125
    v_sub_f32 v56, v49, v56
    v_sub_f32 v57, v53, v57
    v_cvt_pk_bf16_f32 v149, v56, v57
    v_lshlrev_b32 v56, 16, v133
    v_and_b32 v57, 0xffff0000, v133
    v_sub_f32 v56, v50, v56
    v_sub_f32 v57, v54, v57
    v_cvt_pk_bf16_f32 v157, v56, v57
    v_lshlrev_b32 v30, 16, v5
    v_mul_f32 v32, s24, v30
    v_fma_f32 v33, v30, s24, -v32
    v_fmac_f32 v33, s25, v30
    v_exp_f32 v31, v32
    s_nop 0
    v_mul_f32 v33, v33, v31
    v_fmac_f32 v31, s26, v33
    v_cvt_pk_bf16_f32 v31, v31, v31
    v_lshlrev_b32 v31, 16, v31
    v_mul_f32 v31, v31, v26
    v_mul_f32 v31, s28, v31
    v_lshlrev_b32 v32, 16, v9
    v_mul_f32 v32, v32, v26
    v_mul_f32 v32, s27, v32
    v_lshlrev_b32 v33, 16, v13
    v_mul_f32 v33, v33, v26
    v_lshlrev_b32 v34, 16, v17
    v_mul_f32 v34, v34, v26
    v_mul_f32 v36, v31, v21
    v_mul_f32 v40, v32, v21
    v_mul_f32 v37, v31, v22
    v_mul_f32 v41, v32, v22
    v_mul_f32 v38, v31, v23
    v_mul_f32 v42, v32, v23
    v_mul_f32 v39, v31, v24
    v_mul_f32 v43, v32, v24
    v_fract_f32 v40, v40
    v_fract_f32 v41, v41
    v_fract_f32 v42, v42
    v_fract_f32 v43, v43
    v_exp_f32 v36, v36
    v_exp_f32 v37, v37
    v_exp_f32 v38, v38
    v_exp_f32 v39, v39
    v_sin_f32 v44, v40
    v_sin_f32 v45, v41
    v_sin_f32 v46, v42
    v_sin_f32 v47, v43
    v_cos_f32 v40, v40
    v_cos_f32 v41, v41
    v_cos_f32 v42, v42
    v_cos_f32 v43, v43
    v_mul_f32 v44, v44, v36
    v_mul_f32 v45, v45, v37
    v_mul_f32 v46, v46, v38
    v_mul_f32 v47, v47, v39
    v_mul_f32 v40, v40, v36
    v_mul_f32 v41, v41, v37
    v_mul_f32 v42, v42, v38
    v_mul_f32 v43, v43, v39
    v_mul_f32 v48, v33, v41
    v_mul_f32 v52, v33, v45
    v_mul_f32 v49, v33, v42
    v_mul_f32 v53, v33, v46
    v_mul_f32 v50, v33, v43
    v_mul_f32 v54, v33, v47
    v_fma_f32 v48, -v34, v45, v48
    v_fma_f32 v52, -v34, v41, -v52
    v_fma_f32 v49, -v34, v46, v49
    v_fma_f32 v53, -v34, v42, -v53
    v_fma_f32 v50, -v34, v47, v50
    v_fma_f32 v54, -v34, v43, -v54
    v_cvt_pk_bf16_f32 v102, v40, v44
    v_cvt_pk_bf16_f32 v118, v48, v52
    v_cvt_pk_bf16_f32 v126, v49, v53
    v_cvt_pk_bf16_f32 v134, v50, v54
    v_lshlrev_b32 v56, 16, v102
    v_and_b32 v57, 0xffff0000, v102
    v_sub_f32 v56, v40, v56
    v_sub_f32 v57, v44, v57
    v_cvt_pk_bf16_f32 v110, v56, v57
    v_lshlrev_b32 v56, 16, v118
    v_and_b32 v57, 0xffff0000, v118
    v_sub_f32 v56, v48, v56
    v_sub_f32 v57, v52, v57
    v_cvt_pk_bf16_f32 v142, v56, v57
    v_lshlrev_b32 v56, 16, v126
    v_and_b32 v57, 0xffff0000, v126
    v_sub_f32 v56, v49, v56
    v_sub_f32 v57, v53, v57
    v_cvt_pk_bf16_f32 v150, v56, v57
    v_lshlrev_b32 v56, 16, v134
    v_and_b32 v57, 0xffff0000, v134
    v_sub_f32 v56, v50, v56
    v_sub_f32 v57, v54, v57
    v_cvt_pk_bf16_f32 v158, v56, v57
    v_and_b32 v30, 0xffff0000, v5
    v_mul_f32 v32, s24, v30
    v_fma_f32 v33, v30, s24, -v32
    v_fmac_f32 v33, s25, v30
    v_exp_f32 v31, v32
    s_nop 0
    v_mul_f32 v33, v33, v31
    v_fmac_f32 v31, s26, v33
    v_cvt_pk_bf16_f32 v31, v31, v31
    v_lshlrev_b32 v31, 16, v31
    v_mul_f32 v31, v31, v26
    v_mul_f32 v31, s28, v31
    v_and_b32 v32, 0xffff0000, v9
    v_mul_f32 v32, v32, v26
    v_mul_f32 v32, s27, v32
    v_and_b32 v33, 0xffff0000, v13
    v_mul_f32 v33, v33, v26
    v_and_b32 v34, 0xffff0000, v17
    v_mul_f32 v34, v34, v26
    v_mul_f32 v36, v31, v21
    v_mul_f32 v40, v32, v21
    v_mul_f32 v37, v31, v22
    v_mul_f32 v41, v32, v22
    v_mul_f32 v38, v31, v23
    v_mul_f32 v42, v32, v23
    v_mul_f32 v39, v31, v24
    v_mul_f32 v43, v32, v24
    v_fract_f32 v40, v40
    v_fract_f32 v41, v41
    v_fract_f32 v42, v42
    v_fract_f32 v43, v43
    v_exp_f32 v36, v36
    v_exp_f32 v37, v37
    v_exp_f32 v38, v38
    v_exp_f32 v39, v39
    v_sin_f32 v44, v40
    v_sin_f32 v45, v41
    v_sin_f32 v46, v42
    v_sin_f32 v47, v43
    v_cos_f32 v40, v40
    v_cos_f32 v41, v41
    v_cos_f32 v42, v42
    v_cos_f32 v43, v43
    v_mul_f32 v44, v44, v36
    v_mul_f32 v45, v45, v37
    v_mul_f32 v46, v46, v38
    v_mul_f32 v47, v47, v39
    v_mul_f32 v40, v40, v36
    v_mul_f32 v41, v41, v37
    v_mul_f32 v42, v42, v38
    v_mul_f32 v43, v43, v39
    v_mul_f32 v48, v33, v41
    v_mul_f32 v52, v33, v45
    v_mul_f32 v49, v33, v42
    v_mul_f32 v53, v33, v46
    v_mul_f32 v50, v33, v43
    v_mul_f32 v54, v33, v47
    v_fma_f32 v48, -v34, v45, v48
    v_fma_f32 v52, -v34, v41, -v52
    v_fma_f32 v49, -v34, v46, v49
    v_fma_f32 v53, -v34, v42, -v53
    v_fma_f32 v50, -v34, v47, v50
    v_fma_f32 v54, -v34, v43, -v54
    v_cvt_pk_bf16_f32 v103, v40, v44
    v_cvt_pk_bf16_f32 v119, v48, v52
    v_cvt_pk_bf16_f32 v127, v49, v53
    v_cvt_pk_bf16_f32 v135, v50, v54
    v_lshlrev_b32 v56, 16, v103
    v_and_b32 v57, 0xffff0000, v103
    v_sub_f32 v56, v40, v56
    v_sub_f32 v57, v44, v57
    v_cvt_pk_bf16_f32 v111, v56, v57
    v_lshlrev_b32 v56, 16, v119
    v_and_b32 v57, 0xffff0000, v119
    v_sub_f32 v56, v48, v56
    v_sub_f32 v57, v52, v57
    v_cvt_pk_bf16_f32 v143, v56, v57
    v_lshlrev_b32 v56, 16, v127
    v_and_b32 v57, 0xffff0000, v127
    v_sub_f32 v56, v49, v56
    v_sub_f32 v57, v53, v57
    v_cvt_pk_bf16_f32 v151, v56, v57
    v_lshlrev_b32 v56, 16, v135
    v_and_b32 v57, 0xffff0000, v135
    v_sub_f32 v56, v50, v56
    v_sub_f32 v57, v54, v57
    v_cvt_pk_bf16_f32 v159, v56, v57
    v_lshlrev_b32 v30, 16, v6
    v_mul_f32 v32, s24, v30
    v_fma_f32 v33, v30, s24, -v32
    v_fmac_f32 v33, s25, v30
    v_exp_f32 v31, v32
    s_nop 0
    v_mul_f32 v33, v33, v31
    v_fmac_f32 v31, s26, v33
    v_cvt_pk_bf16_f32 v31, v31, v31
    v_lshlrev_b32 v31, 16, v31
    v_mul_f32 v31, v31, v26
    v_mul_f32 v31, s28, v31
    v_lshlrev_b32 v32, 16, v10
    v_mul_f32 v32, v32, v26
    v_mul_f32 v32, s27, v32
    v_lshlrev_b32 v33, 16, v14
    v_mul_f32 v33, v33, v26
    v_lshlrev_b32 v34, 16, v18
    v_mul_f32 v34, v34, v26
    v_mul_f32 v36, v31, v21
    v_mul_f32 v40, v32, v21
    v_mul_f32 v37, v31, v22
    v_mul_f32 v41, v32, v22
    v_mul_f32 v38, v31, v23
    v_mul_f32 v42, v32, v23
    v_mul_f32 v39, v31, v24
    v_mul_f32 v43, v32, v24
    v_fract_f32 v40, v40
    v_fract_f32 v41, v41
    v_fract_f32 v42, v42
    v_fract_f32 v43, v43
    v_exp_f32 v36, v36
    v_exp_f32 v37, v37
    v_exp_f32 v38, v38
    v_exp_f32 v39, v39
    v_sin_f32 v44, v40
    v_sin_f32 v45, v41
    v_sin_f32 v46, v42
    v_sin_f32 v47, v43
    v_cos_f32 v40, v40
    v_cos_f32 v41, v41
    v_cos_f32 v42, v42
    v_cos_f32 v43, v43
    v_mul_f32 v44, v44, v36
    v_mul_f32 v45, v45, v37
    v_mul_f32 v46, v46, v38
    v_mul_f32 v47, v47, v39
    v_mul_f32 v40, v40, v36
    v_mul_f32 v41, v41, v37
    v_mul_f32 v42, v42, v38
    v_mul_f32 v43, v43, v39
    v_mul_f32 v48, v33, v41
    v_mul_f32 v52, v33, v45
    v_mul_f32 v49, v33, v42
    v_mul_f32 v53, v33, v46
    v_mul_f32 v50, v33, v43
    v_mul_f32 v54, v33, v47
    v_fma_f32 v48, -v34, v45, v48
    v_fma_f32 v52, -v34, v41, -v52
    v_fma_f32 v49, -v34, v46, v49
    v_fma_f32 v53, -v34, v42, -v53
    v_fma_f32 v50, -v34, v47, v50
    v_fma_f32 v54, -v34, v43, -v54
    v_cvt_pk_bf16_f32 v104, v40, v44
    v_cvt_pk_bf16_f32 v120, v48, v52
    v_cvt_pk_bf16_f32 v128, v49, v53
    v_cvt_pk_bf16_f32 v136, v50, v54
    v_lshlrev_b32 v56, 16, v104
    v_and_b32 v57, 0xffff0000, v104
    v_sub_f32 v56, v40, v56
    v_sub_f32 v57, v44, v57
    v_cvt_pk_bf16_f32 v112, v56, v57
    v_lshlrev_b32 v56, 16, v120
    v_and_b32 v57, 0xffff0000, v120
    v_sub_f32 v56, v48, v56
    v_sub_f32 v57, v52, v57
    v_cvt_pk_bf16_f32 v144, v56, v57
    v_lshlrev_b32 v56, 16, v128
    v_and_b32 v57, 0xffff0000, v128
    v_sub_f32 v56, v49, v56
    v_sub_f32 v57, v53, v57
    v_cvt_pk_bf16_f32 v152, v56, v57
    v_lshlrev_b32 v56, 16, v136
    v_and_b32 v57, 0xffff0000, v136
    v_sub_f32 v56, v50, v56
    v_sub_f32 v57, v54, v57
    v_cvt_pk_bf16_f32 v160, v56, v57
    v_and_b32 v30, 0xffff0000, v6
    v_mul_f32 v32, s24, v30
    v_fma_f32 v33, v30, s24, -v32
    v_fmac_f32 v33, s25, v30
    v_exp_f32 v31, v32
    s_nop 0
    v_mul_f32 v33, v33, v31
    v_fmac_f32 v31, s26, v33
    v_cvt_pk_bf16_f32 v31, v31, v31
    v_lshlrev_b32 v31, 16, v31
    v_mul_f32 v31, v31, v26
    v_mul_f32 v31, s28, v31
    v_and_b32 v32, 0xffff0000, v10
    v_mul_f32 v32, v32, v26
    v_mul_f32 v32, s27, v32
    v_and_b32 v33, 0xffff0000, v14
    v_mul_f32 v33, v33, v26
    v_and_b32 v34, 0xffff0000, v18
    v_mul_f32 v34, v34, v26
    v_mul_f32 v36, v31, v21
    v_mul_f32 v40, v32, v21
    v_mul_f32 v37, v31, v22
    v_mul_f32 v41, v32, v22
    v_mul_f32 v38, v31, v23
    v_mul_f32 v42, v32, v23
    v_mul_f32 v39, v31, v24
    v_mul_f32 v43, v32, v24
    v_fract_f32 v40, v40
    v_fract_f32 v41, v41
    v_fract_f32 v42, v42
    v_fract_f32 v43, v43
    v_exp_f32 v36, v36
    v_exp_f32 v37, v37
    v_exp_f32 v38, v38
    v_exp_f32 v39, v39
    v_sin_f32 v44, v40
    v_sin_f32 v45, v41
    v_sin_f32 v46, v42
    v_sin_f32 v47, v43
    v_cos_f32 v40, v40
    v_cos_f32 v41, v41
    v_cos_f32 v42, v42
    v_cos_f32 v43, v43
    v_mul_f32 v44, v44, v36
    v_mul_f32 v45, v45, v37
    v_mul_f32 v46, v46, v38
    v_mul_f32 v47, v47, v39
    v_mul_f32 v40, v40, v36
    v_mul_f32 v41, v41, v37
    v_mul_f32 v42, v42, v38
    v_mul_f32 v43, v43, v39
    v_mul_f32 v48, v33, v41
    v_mul_f32 v52, v33, v45
    v_mul_f32 v49, v33, v42
    v_mul_f32 v53, v33, v46
    v_mul_f32 v50, v33, v43
    v_mul_f32 v54, v33, v47
    v_fma_f32 v48, -v34, v45, v48
    v_fma_f32 v52, -v34, v41, -v52
    v_fma_f32 v49, -v34, v46, v49
    v_fma_f32 v53, -v34, v42, -v53
    v_fma_f32 v50, -v34, v47, v50
    v_fma_f32 v54, -v34, v43, -v54
    v_cvt_pk_bf16_f32 v105, v40, v44
    v_cvt_pk_bf16_f32 v121, v48, v52
    v_cvt_pk_bf16_f32 v129, v49, v53
    v_cvt_pk_bf16_f32 v137, v50, v54
    v_lshlrev_b32 v56, 16, v105
    v_and_b32 v57, 0xffff0000, v105
    v_sub_f32 v56, v40, v56
    v_sub_f32 v57, v44, v57
    v_cvt_pk_bf16_f32 v113, v56, v57
    v_lshlrev_b32 v56, 16, v121
    v_and_b32 v57, 0xffff0000, v121
    v_sub_f32 v56, v48, v56
    v_sub_f32 v57, v52, v57
    v_cvt_pk_bf16_f32 v145, v56, v57
    v_lshlrev_b32 v56, 16, v129
    v_and_b32 v57, 0xffff0000, v129
    v_sub_f32 v56, v49, v56
    v_sub_f32 v57, v53, v57
    v_cvt_pk_bf16_f32 v153, v56, v57
    v_lshlrev_b32 v56, 16, v137
    v_and_b32 v57, 0xffff0000, v137
    v_sub_f32 v56, v50, v56
    v_sub_f32 v57, v54, v57
    v_cvt_pk_bf16_f32 v161, v56, v57
    v_lshlrev_b32 v30, 16, v7
    v_mul_f32 v32, s24, v30
    v_fma_f32 v33, v30, s24, -v32
    v_fmac_f32 v33, s25, v30
    v_exp_f32 v31, v32
    s_nop 0
    v_mul_f32 v33, v33, v31
    v_fmac_f32 v31, s26, v33
    v_cvt_pk_bf16_f32 v31, v31, v31
    v_lshlrev_b32 v31, 16, v31
    v_mul_f32 v31, v31, v26
    v_mul_f32 v31, s28, v31
    v_lshlrev_b32 v32, 16, v11
    v_mul_f32 v32, v32, v26
    v_mul_f32 v32, s27, v32
    v_lshlrev_b32 v33, 16, v15
    v_mul_f32 v33, v33, v26
    v_lshlrev_b32 v34, 16, v19
    v_mul_f32 v34, v34, v26
    v_mul_f32 v36, v31, v21
    v_mul_f32 v40, v32, v21
    v_mul_f32 v37, v31, v22
    v_mul_f32 v41, v32, v22
    v_mul_f32 v38, v31, v23
    v_mul_f32 v42, v32, v23
    v_mul_f32 v39, v31, v24
    v_mul_f32 v43, v32, v24
    v_fract_f32 v40, v40
    v_fract_f32 v41, v41
    v_fract_f32 v42, v42
    v_fract_f32 v43, v43
    v_exp_f32 v36, v36
    v_exp_f32 v37, v37
    v_exp_f32 v38, v38
    v_exp_f32 v39, v39
    v_sin_f32 v44, v40
    v_sin_f32 v45, v41
    v_sin_f32 v46, v42
    v_sin_f32 v47, v43
    v_cos_f32 v40, v40
    v_cos_f32 v41, v41
    v_cos_f32 v42, v42
    v_cos_f32 v43, v43
    v_mul_f32 v44, v44, v36
    v_mul_f32 v45, v45, v37
    v_mul_f32 v46, v46, v38
    v_mul_f32 v47, v47, v39
    v_mul_f32 v40, v40, v36
    v_mul_f32 v41, v41, v37
    v_mul_f32 v42, v42, v38
    v_mul_f32 v43, v43, v39
    v_mul_f32 v48, v33, v41
    v_mul_f32 v52, v33, v45
    v_mul_f32 v49, v33, v42
    v_mul_f32 v53, v33, v46
    v_mul_f32 v50, v33, v43
    v_mul_f32 v54, v33, v47
    v_fma_f32 v48, -v34, v45, v48
    v_fma_f32 v52, -v34, v41, -v52
    v_fma_f32 v49, -v34, v46, v49
    v_fma_f32 v53, -v34, v42, -v53
    v_fma_f32 v50, -v34, v47, v50
    v_fma_f32 v54, -v34, v43, -v54
    v_cvt_pk_bf16_f32 v106, v40, v44
    v_cvt_pk_bf16_f32 v122, v48, v52
    v_cvt_pk_bf16_f32 v130, v49, v53
    v_cvt_pk_bf16_f32 v138, v50, v54
    v_lshlrev_b32 v56, 16, v106
    v_and_b32 v57, 0xffff0000, v106
    v_sub_f32 v56, v40, v56
    v_sub_f32 v57, v44, v57
    v_cvt_pk_bf16_f32 v114, v56, v57
    v_lshlrev_b32 v56, 16, v122
    v_and_b32 v57, 0xffff0000, v122
    v_sub_f32 v56, v48, v56
    v_sub_f32 v57, v52, v57
    v_cvt_pk_bf16_f32 v146, v56, v57
    v_lshlrev_b32 v56, 16, v130
    v_and_b32 v57, 0xffff0000, v130
    v_sub_f32 v56, v49, v56
    v_sub_f32 v57, v53, v57
    v_cvt_pk_bf16_f32 v154, v56, v57
    v_lshlrev_b32 v56, 16, v138
    v_and_b32 v57, 0xffff0000, v138
    v_sub_f32 v56, v50, v56
    v_sub_f32 v57, v54, v57
    v_cvt_pk_bf16_f32 v162, v56, v57
    v_and_b32 v30, 0xffff0000, v7
    v_mul_f32 v32, s24, v30
    v_fma_f32 v33, v30, s24, -v32
    v_fmac_f32 v33, s25, v30
    v_exp_f32 v31, v32
    s_nop 0
    v_mul_f32 v33, v33, v31
    v_fmac_f32 v31, s26, v33
    v_cvt_pk_bf16_f32 v31, v31, v31
    v_lshlrev_b32 v31, 16, v31
    v_mul_f32 v31, v31, v26
    v_mul_f32 v31, s28, v31
    v_and_b32 v32, 0xffff0000, v11
    v_mul_f32 v32, v32, v26
    v_mul_f32 v32, s27, v32
    v_and_b32 v33, 0xffff0000, v15
    v_mul_f32 v33, v33, v26
    v_and_b32 v34, 0xffff0000, v19
    v_mul_f32 v34, v34, v26
    v_mul_f32 v36, v31, v21
    v_mul_f32 v40, v32, v21
    v_mul_f32 v37, v31, v22
    v_mul_f32 v41, v32, v22
    v_mul_f32 v38, v31, v23
    v_mul_f32 v42, v32, v23
    v_mul_f32 v39, v31, v24
    v_mul_f32 v43, v32, v24
    v_fract_f32 v40, v40
    v_fract_f32 v41, v41
    v_fract_f32 v42, v42
    v_fract_f32 v43, v43
    v_exp_f32 v36, v36
    v_exp_f32 v37, v37
    v_exp_f32 v38, v38
    v_exp_f32 v39, v39
    v_sin_f32 v44, v40
    v_sin_f32 v45, v41
    v_sin_f32 v46, v42
    v_sin_f32 v47, v43
    v_cos_f32 v40, v40
    v_cos_f32 v41, v41
    v_cos_f32 v42, v42
    v_cos_f32 v43, v43
    v_mul_f32 v44, v44, v36
    v_mul_f32 v45, v45, v37
    v_mul_f32 v46, v46, v38
    v_mul_f32 v47, v47, v39
    v_mul_f32 v40, v40, v36
    v_mul_f32 v41, v41, v37
    v_mul_f32 v42, v42, v38
    v_mul_f32 v43, v43, v39
    v_mul_f32 v48, v33, v41
    v_mul_f32 v52, v33, v45
    v_mul_f32 v49, v33, v42
    v_mul_f32 v53, v33, v46
    v_mul_f32 v50, v33, v43
    v_mul_f32 v54, v33, v47
    v_fma_f32 v48, -v34, v45, v48
    v_fma_f32 v52, -v34, v41, -v52
    v_fma_f32 v49, -v34, v46, v49
    v_fma_f32 v53, -v34, v42, -v53
    v_fma_f32 v50, -v34, v47, v50
    v_fma_f32 v54, -v34, v43, -v54
    v_cvt_pk_bf16_f32 v107, v40, v44
    v_cvt_pk_bf16_f32 v123, v48, v52
    v_cvt_pk_bf16_f32 v131, v49, v53
    v_cvt_pk_bf16_f32 v139, v50, v54
    v_lshlrev_b32 v56, 16, v107
    v_and_b32 v57, 0xffff0000, v107
    v_sub_f32 v56, v40, v56
    v_sub_f32 v57, v44, v57
    v_cvt_pk_bf16_f32 v115, v56, v57
    v_lshlrev_b32 v56, 16, v123
    v_and_b32 v57, 0xffff0000, v123
    v_sub_f32 v56, v48, v56
    v_sub_f32 v57, v52, v57
    v_cvt_pk_bf16_f32 v147, v56, v57
    v_lshlrev_b32 v56, 16, v131
    v_and_b32 v57, 0xffff0000, v131
    v_sub_f32 v56, v49, v56
    v_sub_f32 v57, v53, v57
    v_cvt_pk_bf16_f32 v155, v56, v57
    v_lshlrev_b32 v56, 16, v139
    v_and_b32 v57, 0xffff0000, v139
    v_sub_f32 v56, v50, v56
    v_sub_f32 v57, v54, v57
    v_cvt_pk_bf16_f32 v163, v56, v57
    v_mfma_f32_16x16x32_bf16 v[164:167], v[100:103], v[116:119], 0
    v_mfma_f32_16x16x32_bf16 v[164:167], v[100:103], v[140:143], v[164:167]
    v_mfma_f32_16x16x32_bf16 v[164:167], v[108:111], v[116:119], v[164:167]
    v_mfma_f32_16x16x32_bf16 v[168:171], v[100:103], v[124:127], 0
    v_mfma_f32_16x16x32_bf16 v[168:171], v[100:103], v[148:151], v[168:171]
    v_mfma_f32_16x16x32_bf16 v[168:171], v[108:111], v[124:127], v[168:171]
    v_mfma_f32_16x16x32_bf16 v[172:175], v[100:103], v[132:135], 0
    v_mfma_f32_16x16x32_bf16 v[172:175], v[100:103], v[156:159], v[172:175]
    v_mfma_f32_16x16x32_bf16 v[172:175], v[108:111], v[132:135], v[172:175]
    v_mfma_f32_16x16x32_bf16 v[164:167], v[104:107], v[120:123], v[164:167]
    v_mfma_f32_16x16x32_bf16 v[164:167], v[104:107], v[144:147], v[164:167]
    v_mfma_f32_16x16x32_bf16 v[164:167], v[112:115], v[120:123], v[164:167]
    v_mfma_f32_16x16x32_bf16 v[168:171], v[104:107], v[128:131], v[168:171]
    v_mfma_f32_16x16x32_bf16 v[168:171], v[104:107], v[152:155], v[168:171]
    v_mfma_f32_16x16x32_bf16 v[168:171], v[112:115], v[128:131], v[168:171]
    v_mfma_f32_16x16x32_bf16 v[172:175], v[104:107], v[136:139], v[172:175]
    v_mfma_f32_16x16x32_bf16 v[172:175], v[104:107], v[160:163], v[172:175]
    v_mfma_f32_16x16x32_bf16 v[172:175], v[112:115], v[136:139], v[172:175]
    v_lshrrev_b32 v28, 6, v0
    v_mul_u32_u24 v28, 3072, v28
    v_and_b32 v29, 63, v0
    v_lshl_add_u32 v28, v29, 4, v28
    ds_write_b128 v28, v[164:167] offset:0
    ds_write_b128 v28, v[168:171] offset:1024
    s_nop 1
    ds_write_b128 v28, v[172:175] offset:2048
    s_waitcnt lgkmcnt(0)
    s_barrier
    v_readfirstlane_b32 s20, v0
    s_nop 0
    s_lshr_b32 s20, s20, 6
    s_cmp_ge_u32 s20, 3
    s_cbranch_scc1 KG_DONE_k1
    s_lshl_b32 s21, s20, 10
    v_lshl_add_u32 v28, v29, 4, s21
    ds_read_b128 v[4:7], v28 offset:0
    ds_read_b128 v[8:11], v28 offset:3072
    ds_read_b128 v[12:15], v28 offset:6144
    ds_read_b128 v[16:19], v28 offset:9216
    v_mov_b32 v29, 0
    ds_read_b128 v[20:23], v29 offset:12288
    s_waitcnt lgkmcnt(0)
    v_add_f32 v4, v4, v8
    v_add_f32 v12, v12, v16
    v_add_f32 v4, v4, v12
    v_add_f32 v5, v5, v9
    v_add_f32 v13, v13, v17
    v_add_f32 v5, v5, v13
    v_add_f32 v6, v6, v10
    v_add_f32 v14, v14, v18
    v_add_f32 v6, v6, v14
    v_add_f32 v7, v7, v11
    v_add_f32 v15, v15, v19
    v_add_f32 v7, v7, v15
    v_add_f32 v20, v20, v21
    v_add_f32 v22, v22, v23
    v_add_f32 v20, v20, v22
    v_mul_f32 v20, v20, v26
    v_add_f32 v20, v20, v20
    v_lshrrev_b32 v20, 23, v20
    v_max_u32 v20, 14, v20
    v_min_u32 v20, 0xfe, v20
    v_sub_u32 v21, 0x10b, v20
    v_lshlrev_b32 v21, 23, v21
    v_subrev_u32 v22, 13, v20
    v_lshlrev_b32 v22, 23, v22
    v_add_f32 v21, v21, v21
    v_mul_f32 v4, v4, v21
    v_mul_f32 v5, v5, v21
    v_mul_f32 v6, v6, v21
    v_mul_f32 v7, v7, v21
    v_cvt_pk_f16_f32 v4, v4, v5
    v_cvt_pk_f16_f32 v5, v6, v7
    v_and_b32 v28, 15, v0
    v_bfe_u32 v29, v0, 4, 2
    v_lshlrev_b32 v28, 5, v28
    v_lshl_or_b32 v28, v29, 3, v28
    s_lshl_b32 s21, s20, 9
    s_lshl_b32 s22, s3, 11
    s_add_u32 s21, s21, s22
    s_add_u32 s21, s21, 0x680000
    buffer_store_dwordx2 v[4:5], v28, s[52:55], s21 offen
    s_cmp_lg_u32 s20, 0
    s_cbranch_scc1 KG_DONE_k1
    v_mov_b32 v28, 0
    s_add_u32 s22, s22, 0x680600
    buffer_store_dword v22, v28, s[52:55], s22 offen
KG_DONE_k1:
    s_waitcnt vmcnt(0) lgkmcnt(0)
    s_barrier
K1_END:
    s_endpgm
.section .rodata,"a"
.p2align 6
.amdhsa_kernel k1_prep_kernel
  .amdhsa_next_free_vgpr 176
  .amdhsa_next_free_sgpr 102
  .amdhsa_accum_offset 176
  .amdhsa_group_segment_fixed_size 0
  .amdhsa_kernarg_size 120
  .amdhsa_user_sgpr_count 2
  .amdhsa_user_sgpr_kernarg_segment_ptr 1
  .amdhsa_system_sgpr_workgroup_id_x 1
.end_amdhsa_kernel
.text
.globl k2_mid_kernel
.p2align 8
.type k2_mid_kernel,@function
k2_mid_kernel:
    s_cmp_ge_u32 s2, 512
    s_cbranch_scc1 K2_END
    s_cmp_ge_u32 s2, 256
    s_cbranch_scc1 K2_CONV
    s_and_b32 s46, s2, 7
    s_lshr_b32 s47, s2, 3
    s_lshr_b32 s48, s47, 3
    s_lshl_b32 s48, s48, 3
    s_add_u32 s46, s46, s48
    s_cmp_ge_u32 s46, 28
    s_cbranch_scc1 K2_END
    s_and_b32 s47, s47, 7
    s_load_dwordx2 s[4:5], s[0:1], 112
    s_load_dwordx2 s[6:7], s[0:1], 64
    s_load_dwordx2 s[20:21], s[0:1], 72
    s_lshl_b32 s48, s47, 7
    s_lshl_b32 s49, s46, 7
    s_waitcnt lgkmcnt(0)
    s_add_u32 s8, s4, 0x200000
    s_addc_u32 s9, s5, 0
    s_mov_b32 s10, 0x200000
    s_mov_b32 s11, 0x20000
    s_mov_b32 s12, s6
    s_mov_b32 s13, s7
    s_mov_b32 s14, 0x700000
    s_mov_b32 s15, 0x20000
    s_mov_b32 s16, s20
    s_mov_b32 s17, s21
    s_mov_b32 s18, 0xe00
    s_mov_b32 s19, 0x20000
    s_mov_b32 s24, s4
    s_mov_b32 s25, s5
    s_mov_b32 s26, 0xc00000
    s_mov_b32 s27, 0x20000
    v_lshrrev_b32 v102, 6, v0
    s_nop 0
    v_readfirstlane_b32 s43, v102
    v_and_b32 v102, 63, v0
    s_mul_i32 s40, s43, 20480
    v_lshrrev_b32 v103, 3, v102
    v_bfe_u32 v104, v102, 4, 1
    v_lshlrev_b32 v104, 2, v104
    v_and_b32 v105, 7, v102
    v_xor_b32 v105, v105, v104
    v_lshlrev_b32 v105, 4, v105
    s_lshl_b32 s44, s43, 4
    v_add_u32 v103, s44, v103
    v_lshlrev_b32 v96, 10, v103
    v_add3_u32 v96, v96, v105, s48
    v_add_u32 v97, 0x2000, v96
    v_mul_u32_u24 v98, 3584, v103
    v_add3_u32 v98, v98, v105, s49
    v_add_u32 v99, 28672, v98
    v_lshrrev_b32 v103, 5, v102
    v_lshlrev_b32 v103, 3, v103
    v_bfe_u32 v104, v102, 2, 2
    v_add_u32 v103, v103, v104
    v_lshlrev_b32 v103, 7, v103
    v_bfe_u32 v104, v102, 4, 1
    v_lshlrev_b32 v104, 5, v104
    v_add_u32 v103, v103, v104
    v_and_b32 v104, 3, v102
    v_lshlrev_b32 v104, 3, v104
    v_add_u32 v103, v103, v104
    v_bfe_u32 v104, v102, 3, 1
    v_lshlrev_b32 v104, 6, v104
    v_add_u32 v103, v103, v104
    v_add_u32 v100, s40, v103
    v_xor_b32 v101, 64, v100
    s_mov_b32 s41, 0
    s_mov_b32 s42, 0
    s_add_u32 m0, s40, 0
    s_nop 0
    buffer_load_dwordx4 v96, s[8:11], s41 offen lds
    s_add_u32 m0, s40, 1024
    s_nop 0
    buffer_load_dwordx4 v97, s[8:11], s41 offen lds
    s_add_u32 m0, s40, 2048
    s_nop 0
    buffer_load_dwordx4 v98, s[12:15], s42 offen lds
    s_add_u32 m0, s40, 3072
    s_nop 0
    buffer_load_dwordx4 v99, s[12:15], s42 offen lds
    s_add_u32 s41, s41, 0x10000
    s_add_u32 s42, s42, 229376
    s_add_u32 m0, s40, 4096
    s_nop 0
    buffer_load_dwordx4 v96, s[8:11], s41 offen lds
    s_add_u32 m0, s40, 5120
    s_nop 0
    buffer_load_dwordx4 v97, s[8:11], s41 offen lds
    s_add_u32 m0, s40, 6144
    s_nop 0
    buffer_load_dwordx4 v98, s[12:15], s42 offen lds
    s_add_u32 m0, s40, 7168
    s_nop 0
    buffer_load_dwordx4 v99, s[12:15], s42 offen lds
    s_add_u32 s41, s41, 0x10000
    s_add_u32 s42, s42, 229376
    s_add_u32 m0, s40, 8192
    s_nop 0
    buffer_load_dwordx4 v96, s[8:11], s41 offen lds
    s_add_u32 m0, s40, 9216
    s_nop 0
    buffer_load_dwordx4 v97, s[8:11], s41 offen lds
    s_add_u32 m0, s40, 10240
    s_nop 0
    buffer_load_dwordx4 v98, s[12:15], s42 offen lds
    s_add_u32 m0, s40, 11264
    s_nop 0
    buffer_load_dwordx4 v99, s[12:15], s42 offen lds
    s_add_u32 s41, s41, 0x10000
    s_add_u32 s42, s42, 229376
    s_add_u32 m0, s40, 12288
    s_nop 0
    buffer_load_dwordx4 v96, s[8:11], s41 offen lds
    s_add_u32 m0, s40, 13312
    s_nop 0
    buffer_load_dwordx4 v97, s[8:11], s41 offen lds
    s_add_u32 m0, s40, 14336
    s_nop 0
    buffer_load_dwordx4 v98, s[12:15], s42 offen lds
    s_add_u32 m0, s40, 15360
    s_nop 0
    buffer_load_dwordx4 v99, s[12:15], s42 offen lds
    s_add_u32 s41, s41, 0x10000
    s_add_u32 s42, s42, 229376
    s_waitcnt vmcnt(12)
    ds_read_b64_tr_b16 v[64:65], v100 offset:0
    ds_read_b64_tr_b16 v[66:67], v100 offset:512
    ds_read_b64_tr_b16 v[68:69], v101 offset:0
    ds_read_b64_tr_b16 v[70:71], v101 offset:512
    ds_read_b64_tr_b16 v[72:73], v100 offset:2048
    ds_read_b64_tr_b16 v[74:75], v100 offset:2560
    ds_read_b64_tr_b16 v[76:77], v101 offset:2048
    ds_read_b64_tr_b16 v[78:79], v101 offset:2560
    s_waitcnt vmcnt(8)
    ds_read_b64_tr_b16 v[80:81], v100 offset:4096
    ds_read_b64_tr_b16 v[82:83], v100 offset:4608
    ds_read_b64_tr_b16 v[84:85], v101 offset:4096
    ds_read_b64_tr_b16 v[86:87], v101 offset:4608
    ds_read_b64_tr_b16 v[88:89], v100 offset:6144
    ds_read_b64_tr_b16 v[90:91], v100 offset:6656
    ds_read_b64_tr_b16 v[92:93], v101 offset:6144
    ds_read_b64_tr_b16 v[94:95], v101 offset:6656
    s_waitcnt lgkmcnt(8)
    v_mfma_f32_32x32x16_bf16 v[0:15], v[64:67], v[72:75], 0
    v_mfma_f32_32x32x16_bf16 v[32:47], v[64:67], v[76:79], 0
    v_mfma_f32_32x32x16_bf16 v[16:31], v[68:71], v[72:75], 0
    v_mfma_f32_32x32x16_bf16 v[48:63], v[68:71], v[76:79], 0
    s_add_u32 m0, s40, 16384
    s_nop 0
    buffer_load_dwordx4 v96, s[8:11], s41 offen lds
    s_add_u32 m0, s40, 17408
    s_nop 0
    buffer_load_dwordx4 v97, s[8:11], s41 offen lds
    s_add_u32 m0, s40, 18432
    s_nop 0
    buffer_load_dwordx4 v98, s[12:15], s42 offen lds
    s_add_u32 m0, s40, 19456
    s_nop 0
    buffer_load_dwordx4 v99, s[12:15], s42 offen lds
    s_add_u32 s41, s41, 0x10000
    s_add_u32 s42, s42, 229376
    s_waitcnt vmcnt(8)
    ds_read_b64_tr_b16 v[64:65], v100 offset:8192
    ds_read_b64_tr_b16 v[66:67], v100 offset:8704
    ds_read_b64_tr_b16 v[68:69], v101 offset:8192
    ds_read_b64_tr_b16 v[70:71], v101 offset:8704
    ds_read_b64_tr_b16 v[72:73], v100 offset:10240
    ds_read_b64_tr_b16 v[74:75], v100 offset:10752
    ds_read_b64_tr_b16 v[76:77], v101 offset:10240
    ds_read_b64_tr_b16 v[78:79], v101 offset:10752
    s_waitcnt lgkmcnt(8)
    v_mfma_f32_32x32x16_bf16 v[0:15], v[80:83], v[88:91], v[0:15]
    v_mfma_f32_32x32x16_bf16 v[32:47], v[80:83], v[92:95], v[32:47]
    v_mfma_f32_32x32x16_bf16 v[16:31], v[84:87], v[88:91], v[16:31]
    v_mfma_f32_32x32x16_bf16 v[48:63], v[84:87], v[92:95], v[48:63]
    s_add_u32 m0, s40, 0
    s_nop 0
    buffer_load_dwordx4 v96, s[8:11], s41 offen lds
    s_add_u32 m0, s40, 1024
    s_nop 0
    buffer_load_dwordx4 v97, s[8:11], s41 offen lds
    s_add_u32 m0, s40, 2048
    s_nop 0
    buffer_load_dwordx4 v98, s[12:15], s42 offen lds
    s_add_u32 m0, s40, 3072
    s_nop 0
    buffer_load_dwordx4 v99, s[12:15], s42 offen lds
    s_add_u32 s41, s41, 0x10000
    s_add_u32 s42, s42, 229376
    s_waitcnt vmcnt(8)
    ds_read_b64_tr_b16 v[80:81], v100 offset:12288
    ds_read_b64_tr_b16 v[82:83], v100 offset:12800
    ds_read_b64_tr_b16 v[84:85], v101 offset:12288
    ds_read_b64_tr_b16 v[86:87], v101 offset:12800
    ds_read_b64_tr_b16 v[88:89], v100 offset:14336
    ds_read_b64_tr_b16 v[90:91], v100 offset:14848
    ds_read_b64_tr_b16 v[92:93], v101 offset:14336
    ds_read_b64_tr_b16 v[94:95], v101 offset:14848
    s_waitcnt lgkmcnt(8)
    v_mfma_f32_32x32x16_bf16 v[0:15], v[64:67], v[72:75], v[0:15]
    v_mfma_f32_32x32x16_bf16 v[32:47], v[64:67], v[76:79], v[32:47]
    v_mfma_f32_32x32x16_bf16 v[16:31], v[68:71], v[72:75], v[16:31]
    v_mfma_f32_32x32x16_bf16 v[48:63], v[68:71], v[76:79], v[48:63]
    s_add_u32 m0, s40, 4096
    s_nop 0
    buffer_load_dwordx4 v96, s[8:11], s41 offen lds
    s_add_u32 m0, s40, 5120
    s_nop 0
    buffer_load_dwordx4 v97, s[8:11], s41 offen lds
    s_add_u32 m0, s40, 6144
    s_nop 0
    buffer_load_dwordx4 v98, s[12:15], s42 offen lds
    s_add_u32 m0, s40, 7168
    s_nop 0
    buffer_load_dwordx4 v99, s[12:15], s42 offen lds
    s_add_u32 s41, s41, 0x10000
    s_add_u32 s42, s42, 229376
    s_waitcnt vmcnt(8)
    ds_read_b64_tr_b16 v[64:65], v100 offset:16384
    ds_read_b64_tr_b16 v[66:67], v100 offset:16896
    ds_read_b64_tr_b16 v[68:69], v101 offset:16384
    ds_read_b64_tr_b16 v[70:71], v101 offset:16896
    ds_read_b64_tr_b16 v[72:73], v100 offset:18432
    ds_read_b64_tr_b16 v[74:75], v100 offset:18944
    ds_read_b64_tr_b16 v[76:77], v101 offset:18432
    ds_read_b64_tr_b16 v[78:79], v101 offset:18944
    s_waitcnt lgkmcnt(8)
    v_mfma_f32_32x32x16_bf16 v[0:15], v[80:83], v[88:91], v[0:15]
    v_mfma_f32_32x32x16_bf16 v[32:47], v[80:83], v[92:95], v[32:47]
    v_mfma_f32_32x32x16_bf16 v[16:31], v[84:87], v[88:91], v[16:31]
    v_mfma_f32_32x32x16_bf16 v[48:63], v[84:87], v[92:95], v[48:63]
    s_add_u32 m0, s40, 8192
    s_nop 0
    buffer_load_dwordx4 v96, s[8:11], s41 offen lds
    s_add_u32 m0, s40, 9216
    s_nop 0
    buffer_load_dwordx4 v97, s[8:11], s41 offen lds
    s_add_u32 m0, s40, 10240
    s_nop 0
    buffer_load_dwordx4 v98, s[12:15], s42 offen lds
    s_add_u32 m0, s40, 11264
    s_nop 0
    buffer_load_dwordx4 v99, s[12:15], s42 offen lds
    s_add_u32 s41, s41, 0x10000
    s_add_u32 s42, s42, 229376
    s_waitcnt vmcnt(8)
    ds_read_b64_tr_b16 v[80:81], v100 offset:0
    ds_read_b64_tr_b16 v[82:83], v100 offset:512
    ds_read_b64_tr_b16 v[84:85], v101 offset:0
    ds_read_b64_tr_b16 v[86:87], v101 offset:512
    ds_read_b64_tr_b16 v[88:89], v100 offset:2048
    ds_read_b64_tr_b16 v[90:91], v100 offset:2560
    ds_read_b64_tr_b16 v[92:93], v101 offset:2048
    ds_read_b64_tr_b16 v[94:95], v101 offset:2560
    s_waitcnt lgkmcnt(8)
    v_mfma_f32_32x32x16_bf16 v[0:15], v[64:67], v[72:75], v[0:15]
    v_mfma_f32_32x32x16_bf16 v[32:47], v[64:67], v[76:79], v[32:47]
    v_mfma_f32_32x32x16_bf16 v[16:31], v[68:71], v[72:75], v[16:31]
    v_mfma_f32_32x32x16_bf16 v[48:63], v[68:71], v[76:79], v[48:63]
    s_add_u32 m0, s40, 12288
    s_nop 0
    buffer_load_dwordx4 v96, s[8:11], s41 offen lds
    s_add_u32 m0, s40, 13312
    s_nop 0
    buffer_load_dwordx4 v97, s[8:11], s41 offen lds
    s_add_u32 m0, s40, 14336
    s_nop 0
    buffer_load_dwordx4 v98, s[12:15], s42 offen lds
    s_add_u32 m0, s40, 15360
    s_nop 0
    buffer_load_dwordx4 v99, s[12:15], s42 offen lds
    s_add_u32 s41, s41, 0x10000
    s_add_u32 s42, s42, 229376
    s_waitcnt vmcnt(8)
    ds_read_b64_tr_b16 v[64:65], v100 offset:4096
    ds_read_b64_tr_b16 v[66:67], v100 offset:4608
    ds_read_b64_tr_b16 v[68:69], v101 offset:4096
    ds_read_b64_tr_b16 v[70:71], v101 offset:4608
    ds_read_b64_tr_b16 v[72:73], v100 offset:6144
    ds_read_b64_tr_b16 v[74:75], v100 offset:6656
    ds_read_b64_tr_b16 v[76:77], v101 offset:6144
    ds_read_b64_tr_b16 v[78:79], v101 offset:6656
    s_waitcnt lgkmcnt(8)
    v_mfma_f32_32x32x16_bf16 v[0:15], v[80:83], v[88:91], v[0:15]
    v_mfma_f32_32x32x16_bf16 v[32:47], v[80:83], v[92:95], v[32:47]
    v_mfma_f32_32x32x16_bf16 v[16:31], v[84:87], v[88:91], v[16:31]
    v_mfma_f32_32x32x16_bf16 v[48:63], v[84:87], v[92:95], v[48:63]
    s_add_u32 m0, s40, 16384
    s_nop 0
    buffer_load_dwordx4 v96, s[8:11], s41 offen lds
    s_add_u32 m0, s40, 17408
    s_nop 0
    buffer_load_dwordx4 v97, s[8:11], s41 offen lds
    s_add_u32 m0, s40, 18432
    s_nop 0
    buffer_load_dwordx4 v98, s[12:15], s42 offen lds
    s_add_u32 m0, s40, 19456
    s_nop 0
    buffer_load_dwordx4 v99, s[12:15], s42 offen lds
    s_add_u32 s41, s41, 0x10000
    s_add_u32 s42, s42, 229376
    s_waitcnt vmcnt(8)
    ds_read_b64_tr_b16 v[80:81], v100 offset:8192
    ds_read_b64_tr_b16 v[82:83], v100 offset:8704
    ds_read_b64_tr_b16 v[84:85], v101 offset:8192
    ds_read_b64_tr_b16 v[86:87], v101 offset:8704
    ds_read_b64_tr_b16 v[88:89], v100 offset:10240
    ds_read_b64_tr_b16 v[90:91], v100 offset:10752
    ds_read_b64_tr_b16 v[92:93], v101 offset:10240
    ds_read_b64_tr_b16 v[94:95], v101 offset:10752
    s_waitcnt lgkmcnt(8)
    v_mfma_f32_32x32x16_bf16 v[0:15], v[64:67], v[72:75], v[0:15]
    v_mfma_f32_32x32x16_bf16 v[32:47], v[64:67], v[76:79], v[32:47]
    v_mfma_f32_32x32x16_bf16 v[16:31], v[68:71], v[72:75], v[16:31]
    v_mfma_f32_32x32x16_bf16 v[48:63], v[68:71], v[76:79], v[48:63]
    s_add_u32 m0, s40, 0
    s_nop 0
    buffer_load_dwordx4 v96, s[8:11], s41 offen lds
    s_add_u32 m0, s40, 1024
    s_nop 0
    buffer_load_dwordx4 v97, s[8:11], s41 offen lds
    s_add_u32 m0, s40, 2048
    s_nop 0
    buffer_load_dwordx4 v98, s[12:15], s42 offen lds
    s_add_u32 m0, s40, 3072
    s_nop 0
    buffer_load_dwordx4 v99, s[12:15], s42 offen lds
    s_add_u32 s41, s41, 0x10000
    s_add_u32 s42, s42, 229376
    s_waitcnt vmcnt(8)
    ds_read_b64_tr_b16 v[64:65], v100 offset:12288
    ds_read_b64_tr_b16 v[66:67], v100 offset:12800
    ds_read_b64_tr_b16 v[68:69], v101 offset:12288
    ds_read_b64_tr_b16 v[70:71], v101 offset:12800
    ds_read_b64_tr_b16 v[72:73], v100 offset:14336
    ds_read_b64_tr_b16 v[74:75], v100 offset:14848
    ds_read_b64_tr_b16 v[76:77], v101 offset:14336
    ds_read_b64_tr_b16 v[78:79], v101 offset:14848
    s_waitcnt lgkmcnt(8)
    v_mfma_f32_32x32x16_bf16 v[0:15], v[80:83], v[88:91], v[0:15]
    v_mfma_f32_32x32x16_bf16 v[32:47], v[80:83], v[92:95], v[32:47]
    v_mfma_f32_32x32x16_bf16 v[16:31], v[84:87], v[88:91], v[16:31]
    v_mfma_f32_32x32x16_bf16 v[48:63], v[84:87], v[92:95], v[48:63]
    s_add_u32 m0, s40, 4096
    s_nop 0
    buffer_load_dwordx4 v96, s[8:11], s41 offen lds
    s_add_u32 m0, s40, 5120
    s_nop 0
    buffer_load_dwordx4 v97, s[8:11], s41 offen lds
    s_add_u32 m0, s40, 6144
    s_nop 0
    buffer_load_dwordx4 v98, s[12:15], s42 offen lds
    s_add_u32 m0, s40, 7168
    s_nop 0
    buffer_load_dwordx4 v99, s[12:15], s42 offen lds
    s_add_u32 s41, s41, 0x10000
    s_add_u32 s42, s42, 229376
    s_waitcnt vmcnt(8)
    ds_read_b64_tr_b16 v[80:81], v100 offset:16384
    ds_read_b64_tr_b16 v[82:83], v100 offset:16896
    ds_read_b64_tr_b16 v[84:85], v101 offset:16384
    ds_read_b64_tr_b16 v[86:87], v101 offset:16896
    ds_read_b64_tr_b16 v[88:89], v100 offset:18432
    ds_read_b64_tr_b16 v[90:91], v100 offset:18944
    ds_read_b64_tr_b16 v[92:93], v101 offset:18432
    ds_read_b64_tr_b16 v[94:95], v101 offset:18944
    s_waitcnt lgkmcnt(8)
    v_mfma_f32_32x32x16_bf16 v[0:15], v[64:67], v[72:75], v[0:15]
    v_mfma_f32_32x32x16_bf16 v[32:47], v[64:67], v[76:79], v[32:47]
    v_mfma_f32_32x32x16_bf16 v[16:31], v[68:71], v[72:75], v[16:31]
    v_mfma_f32_32x32x16_bf16 v[48:63], v[68:71], v[76:79], v[48:63]
    s_add_u32 m0, s40, 8192
    s_nop 0
    buffer_load_dwordx4 v96, s[8:11], s41 offen lds
    s_add_u32 m0, s40, 9216
    s_nop 0
    buffer_load_dwordx4 v97, s[8:11], s41 offen lds
    s_add_u32 m0, s40, 10240
    s_nop 0
    buffer_load_dwordx4 v98, s[12:15], s42 offen lds
    s_add_u32 m0, s40, 11264
    s_nop 0
    buffer_load_dwordx4 v99, s[12:15], s42 offen lds
    s_add_u32 s41, s41, 0x10000
    s_add_u32 s42, s42, 229376
    s_waitcnt vmcnt(8)
    ds_read_b64_tr_b16 v[64:65], v100 offset:0
    ds_read_b64_tr_b16 v[66:67], v100 offset:512
    ds_read_b64_tr_b16 v[68:69], v101 offset:0
    ds_read_b64_tr_b16 v[70:71], v101 offset:512
    ds_read_b64_tr_b16 v[72:73], v100 offset:2048
    ds_read_b64_tr_b16 v[74:75], v100 offset:2560
    ds_read_b64_tr_b16 v[76:77], v101 offset:2048
    ds_read_b64_tr_b16 v[78:79], v101 offset:2560
    s_waitcnt lgkmcnt(8)
    v_mfma_f32_32x32x16_bf16 v[0:15], v[80:83], v[88:91], v[0:15]
    v_mfma_f32_32x32x16_bf16 v[32:47], v[80:83], v[92:95], v[32:47]
    v_mfma_f32_32x32x16_bf16 v[16:31], v[84:87], v[88:91], v[16:31]
    v_mfma_f32_32x32x16_bf16 v[48:63], v[84:87], v[92:95], v[48:63]
    s_add_u32 m0, s40, 12288
    s_nop 0
    buffer_load_dwordx4 v96, s[8:11], s41 offen lds
    s_add_u32 m0, s40, 13312
    s_nop 0
    buffer_load_dwordx4 v97, s[8:11], s41 offen lds
    s_add_u32 m0, s40, 14336
    s_nop 0
    buffer_load_dwordx4 v98, s[12:15], s42 offen lds
    s_add_u32 m0, s40, 15360
    s_nop 0
    buffer_load_dwordx4 v99, s[12:15], s42 offen lds
    s_add_u32 s41, s41, 0x10000
    s_add_u32 s42, s42, 229376
    s_waitcnt vmcnt(8)
    ds_read_b64_tr_b16 v[80:81], v100 offset:4096
    ds_read_b64_tr_b16 v[82:83], v100 offset:4608
    ds_read_b64_tr_b16 v[84:85], v101 offset:4096
    ds_read_b64_tr_b16 v[86:87], v101 offset:4608
    ds_read_b64_tr_b16 v[88:89], v100 offset:6144
    ds_read_b64_tr_b16 v[90:91], v100 offset:6656
    ds_read_b64_tr_b16 v[92:93], v101 offset:6144
    ds_read_b64_tr_b16 v[94:95], v101 offset:6656
    s_waitcnt lgkmcnt(8)
    v_mfma_f32_32x32x16_bf16 v[0:15], v[64:67], v[72:75], v[0:15]
    v_mfma_f32_32x32x16_bf16 v[32:47], v[64:67], v[76:79], v[32:47]
    v_mfma_f32_32x32x16_bf16 v[16:31], v[68:71], v[72:75], v[16:31]
    v_mfma_f32_32x32x16_bf16 v[48:63], v[68:71], v[76:79], v[48:63]
    s_add_u32 m0, s40, 16384
    s_nop 0
    buffer_load_dwordx4 v96, s[8:11], s41 offen lds
    s_add_u32 m0, s40, 17408
    s_nop 0
    buffer_load_dwordx4 v97, s[8:11], s41 offen lds
    s_add_u32 m0, s40, 18432
    s_nop 0
    buffer_load_dwordx4 v98, s[12:15], s42 offen lds
    s_add_u32 m0, s40, 19456
    s_nop 0
    buffer_load_dwordx4 v99, s[12:15], s42 offen lds
    s_add_u32 s41, s41, 0x10000
    s_add_u32 s42, s42, 229376
    s_waitcnt vmcnt(8)
    ds_read_b64_tr_b16 v[64:65], v100 offset:8192
    ds_read_b64_tr_b16 v[66:67], v100 offset:8704
    ds_read_b64_tr_b16 v[68:69], v101 offset:8192
    ds_read_b64_tr_b16 v[70:71], v101 offset:8704
    ds_read_b64_tr_b16 v[72:73], v100 offset:10240
    ds_read_b64_tr_b16 v[74:75], v100 offset:10752
    ds_read_b64_tr_b16 v[76:77], v101 offset:10240
    ds_read_b64_tr_b16 v[78:79], v101 offset:10752
    s_waitcnt lgkmcnt(8)
    v_mfma_f32_32x32x16_bf16 v[0:15], v[80:83], v[88:91], v[0:15]
    v_mfma_f32_32x32x16_bf16 v[32:47], v[80:83], v[92:95], v[32:47]
    v_mfma_f32_32x32x16_bf16 v[16:31], v[84:87], v[88:91], v[16:31]
    v_mfma_f32_32x32x16_bf16 v[48:63], v[84:87], v[92:95], v[48:63]
    s_add_u32 m0, s40, 0
    s_nop 0
    buffer_load_dwordx4 v96, s[8:11], s41 offen lds
    s_add_u32 m0, s40, 1024
    s_nop 0
    buffer_load_dwordx4 v97, s[8:11], s41 offen lds
    s_add_u32 m0, s40, 2048
    s_nop 0
    buffer_load_dwordx4 v98, s[12:15], s42 offen lds
    s_add_u32 m0, s40, 3072
    s_nop 0
    buffer_load_dwordx4 v99, s[12:15], s42 offen lds
    s_add_u32 s41, s41, 0x10000
    s_add_u32 s42, s42, 229376
    s_waitcnt vmcnt(8)
    ds_read_b64_tr_b16 v[80:81], v100 offset:12288
    ds_read_b64_tr_b16 v[82:83], v100 offset:12800
    ds_read_b64_tr_b16 v[84:85], v101 offset:12288
    ds_read_b64_tr_b16 v[86:87], v101 offset:12800
    ds_read_b64_tr_b16 v[88:89], v100 offset:14336
    ds_read_b64_tr_b16 v[90:91], v100 offset:14848
    ds_read_b64_tr_b16 v[92:93], v101 offset:14336
    ds_read_b64_tr_b16 v[94:95], v101 offset:14848
    s_waitcnt lgkmcnt(8)
    v_mfma_f32_32x32x16_bf16 v[0:15], v[64:67], v[72:75], v[0:15]
    v_mfma_f32_32x32x16_bf16 v[32:47], v[64:67], v[76:79], v[32:47]
    v_mfma_f32_32x32x16_bf16 v[16:31], v[68:71], v[72:75], v[16:31]
    v_mfma_f32_32x32x16_bf16 v[48:63], v[68:71], v[76:79], v[48:63]
    s_add_u32 m0, s40, 4096
    s_nop 0
    buffer_load_dwordx4 v96, s[8:11], s41 offen lds
    s_add_u32 m0, s40, 5120
    s_nop 0
    buffer_load_dwordx4 v97, s[8:11], s41 offen lds
    s_add_u32 m0, s40, 6144
    s_nop 0
    buffer_load_dwordx4 v98, s[12:15], s42 offen lds
    s_add_u32 m0, s40, 7168
    s_nop 0
    buffer_load_dwordx4 v99, s[12:15], s42 offen lds
    s_add_u32 s41, s41, 0x10000
    s_add_u32 s42, s42, 229376
    s_waitcnt vmcnt(8)
    ds_read_b64_tr_b16 v[64:65], v100 offset:16384
    ds_read_b64_tr_b16 v[66:67], v100 offset:16896
    ds_read_b64_tr_b16 v[68:69], v101 offset:16384
    ds_read_b64_tr_b16 v[70:71], v101 offset:16896
    ds_read_b64_tr_b16 v[72:73], v100 offset:18432
    ds_read_b64_tr_b16 v[74:75], v100 offset:18944
    ds_read_b64_tr_b16 v[76:77], v101 offset:18432
    ds_read_b64_tr_b16 v[78:79], v101 offset:18944
    s_waitcnt lgkmcnt(8)
    v_mfma_f32_32x32x16_bf16 v[0:15], v[80:83], v[88:91], v[0:15]
    v_mfma_f32_32x32x16_bf16 v[32:47], v[80:83], v[92:95], v[32:47]
    v_mfma_f32_32x32x16_bf16 v[16:31], v[84:87], v[88:91], v[16:31]
    v_mfma_f32_32x32x16_bf16 v[48:63], v[84:87], v[92:95], v[48:63]
    s_add_u32 m0, s40, 8192
    s_nop 0
    buffer_load_dwordx4 v96, s[8:11], s41 offen lds
    s_add_u32 m0, s40, 9216
    s_nop 0
    buffer_load_dwordx4 v97, s[8:11], s41 offen lds
    s_add_u32 m0, s40, 10240
    s_nop 0
    buffer_load_dwordx4 v98, s[12:15], s42 offen lds
    s_add_u32 m0, s40, 11264
    s_nop 0
    buffer_load_dwordx4 v99, s[12:15], s42 offen lds
    s_add_u32 s41, s41, 0x10000
    s_add_u32 s42, s42, 229376
    s_waitcnt vmcnt(8)
    ds_read_b64_tr_b16 v[80:81], v100 offset:0
    ds_read_b64_tr_b16 v[82:83], v100 offset:512
    ds_read_b64_tr_b16 v[84:85], v101 offset:0
    ds_read_b64_tr_b16 v[86:87], v101 offset:512
    ds_read_b64_tr_b16 v[88:89], v100 offset:2048
    ds_read_b64_tr_b16 v[90:91], v100 offset:2560
    ds_read_b64_tr_b16 v[92:93], v101 offset:2048
    ds_read_b64_tr_b16 v[94:95], v101 offset:2560
    s_waitcnt lgkmcnt(8)
    v_mfma_f32_32x32x16_bf16 v[0:15], v[64:67], v[72:75], v[0:15]
    v_mfma_f32_32x32x16_bf16 v[32:47], v[64:67], v[76:79], v[32:47]
    v_mfma_f32_32x32x16_bf16 v[16:31], v[68:71], v[72:75], v[16:31]
    v_mfma_f32_32x32x16_bf16 v[48:63], v[68:71], v[76:79], v[48:63]
    s_add_u32 m0, s40, 12288
    s_nop 0
    buffer_load_dwordx4 v96, s[8:11], s41 offen lds
    s_add_u32 m0, s40, 13312
    s_nop 0
    buffer_load_dwordx4 v97, s[8:11], s41 offen lds
    s_add_u32 m0, s40, 14336
    s_nop 0
    buffer_load_dwordx4 v98, s[12:15], s42 offen lds
    s_add_u32 m0, s40, 15360
    s_nop 0
    buffer_load_dwordx4 v99, s[12:15], s42 offen lds
    s_add_u32 s41, s41, 0x10000
    s_add_u32 s42, s42, 229376
    s_waitcnt vmcnt(8)
    ds_read_b64_tr_b16 v[64:65], v100 offset:4096
    ds_read_b64_tr_b16 v[66:67], v100 offset:4608
    ds_read_b64_tr_b16 v[68:69], v101 offset:4096
    ds_read_b64_tr_b16 v[70:71], v101 offset:4608
    ds_read_b64_tr_b16 v[72:73], v100 offset:6144
    ds_read_b64_tr_b16 v[74:75], v100 offset:6656
    ds_read_b64_tr_b16 v[76:77], v101 offset:6144
    ds_read_b64_tr_b16 v[78:79], v101 offset:6656
    s_waitcnt lgkmcnt(8)
    v_mfma_f32_32x32x16_bf16 v[0:15], v[80:83], v[88:91], v[0:15]
    v_mfma_f32_32x32x16_bf16 v[32:47], v[80:83], v[92:95], v[32:47]
    v_mfma_f32_32x32x16_bf16 v[16:31], v[84:87], v[88:91], v[16:31]
    v_mfma_f32_32x32x16_bf16 v[48:63], v[84:87], v[92:95], v[48:63]
    s_add_u32 m0, s40, 16384
    s_nop 0
    buffer_load_dwordx4 v96, s[8:11], s41 offen lds
    s_add_u32 m0, s40, 17408
    s_nop 0
    buffer_load_dwordx4 v97, s[8:11], s41 offen lds
    s_add_u32 m0, s40, 18432
    s_nop 0
    buffer_load_dwordx4 v98, s[12:15], s42 offen lds
    s_add_u32 m0, s40, 19456
    s_nop 0
    buffer_load_dwordx4 v99, s[12:15], s42 offen lds
    s_add_u32 s41, s41, 0x10000
    s_add_u32 s42, s42, 229376
    s_waitcnt vmcnt(8)
    ds_read_b64_tr_b16 v[80:81], v100 offset:8192
    ds_read_b64_tr_b16 v[82:83], v100 offset:8704
    ds_read_b64_tr_b16 v[84:85], v101 offset:8192
    ds_read_b64_tr_b16 v[86:87], v101 offset:8704
    ds_read_b64_tr_b16 v[88:89], v100 offset:10240
    ds_read_b64_tr_b16 v[90:91], v100 offset:10752
    ds_read_b64_tr_b16 v[92:93], v101 offset:10240
    ds_read_b64_tr_b16 v[94:95], v101 offset:10752
    s_waitcnt lgkmcnt(8)
    v_mfma_f32_32x32x16_bf16 v[0:15], v[64:67], v[72:75], v[0:15]
    v_mfma_f32_32x32x16_bf16 v[32:47], v[64:67], v[76:79], v[32:47]
    v_mfma_f32_32x32x16_bf16 v[16:31], v[68:71], v[72:75], v[16:31]
    v_mfma_f32_32x32x16_bf16 v[48:63], v[68:71], v[76:79], v[48:63]
    s_add_u32 m0, s40, 0
    s_nop 0
    buffer_load_dwordx4 v96, s[8:11], s41 offen lds
    s_add_u32 m0, s40, 1024
    s_nop 0
    buffer_load_dwordx4 v97, s[8:11], s41 offen lds
    s_add_u32 m0, s40, 2048
    s_nop 0
    buffer_load_dwordx4 v98, s[12:15], s42 offen lds
    s_add_u32 m0, s40, 3072
    s_nop 0
    buffer_load_dwordx4 v99, s[12:15], s42 offen lds
    s_add_u32 s41, s41, 0x10000
    s_add_u32 s42, s42, 229376
    s_waitcnt vmcnt(8)
    ds_read_b64_tr_b16 v[64:65], v100 offset:12288
    ds_read_b64_tr_b16 v[66:67], v100 offset:12800
    ds_read_b64_tr_b16 v[68:69], v101 offset:12288
    ds_read_b64_tr_b16 v[70:71], v101 offset:12800
    ds_read_b64_tr_b16 v[72:73], v100 offset:14336
    ds_read_b64_tr_b16 v[74:75], v100 offset:14848
    ds_read_b64_tr_b16 v[76:77], v101 offset:14336
    ds_read_b64_tr_b16 v[78:79], v101 offset:14848
    s_waitcnt lgkmcnt(8)
    v_mfma_f32_32x32x16_bf16 v[0:15], v[80:83], v[88:91], v[0:15]
    v_mfma_f32_32x32x16_bf16 v[32:47], v[80:83], v[92:95], v[32:47]
    v_mfma_f32_32x32x16_bf16 v[16:31], v[84:87], v[88:91], v[16:31]
    v_mfma_f32_32x32x16_bf16 v[48:63], v[84:87], v[92:95], v[48:63]
    s_add_u32 m0, s40, 4096
    s_nop 0
    buffer_load_dwordx4 v96, s[8:11], s41 offen lds
    s_add_u32 m0, s40, 5120
    s_nop 0
    buffer_load_dwordx4 v97, s[8:11], s41 offen lds
    s_add_u32 m0, s40, 6144
    s_nop 0
    buffer_load_dwordx4 v98, s[12:15], s42 offen lds
    s_add_u32 m0, s40, 7168
    s_nop 0
    buffer_load_dwordx4 v99, s[12:15], s42 offen lds
    s_add_u32 s41, s41, 0x10000
    s_add_u32 s42, s42, 229376
    s_waitcnt vmcnt(8)
    ds_read_b64_tr_b16 v[80:81], v100 offset:16384
    ds_read_b64_tr_b16 v[82:83], v100 offset:16896
    ds_read_b64_tr_b16 v[84:85], v101 offset:16384
    ds_read_b64_tr_b16 v[86:87], v101 offset:16896
    ds_read_b64_tr_b16 v[88:89], v100 offset:18432
    ds_read_b64_tr_b16 v[90:91], v100 offset:18944
    ds_read_b64_tr_b16 v[92:93], v101 offset:18432
    ds_read_b64_tr_b16 v[94:95], v101 offset:18944
    s_waitcnt lgkmcnt(8)
    v_mfma_f32_32x32x16_bf16 v[0:15], v[64:67], v[72:75], v[0:15]
    v_mfma_f32_32x32x16_bf16 v[32:47], v[64:67], v[76:79], v[32:47]
    v_mfma_f32_32x32x16_bf16 v[16:31], v[68:71], v[72:75], v[16:31]
    v_mfma_f32_32x32x16_bf16 v[48:63], v[68:71], v[76:79], v[48:63]
    s_add_u32 m0, s40, 8192
    s_nop 0
    buffer_load_dwordx4 v96, s[8:11], s41 offen lds
    s_add_u32 m0, s40, 9216
    s_nop 0
    buffer_load_dwordx4 v97, s[8:11], s41 offen lds
    s_add_u32 m0, s40, 10240
    s_nop 0
    buffer_load_dwordx4 v98, s[12:15], s42 offen lds
    s_add_u32 m0, s40, 11264
    s_nop 0
    buffer_load_dwordx4 v99, s[12:15], s42 offen lds
    s_add_u32 s41, s41, 0x10000
    s_add_u32 s42, s42, 229376
    s_waitcnt vmcnt(8)
    ds_read_b64_tr_b16 v[64:65], v100 offset:0
    ds_read_b64_tr_b16 v[66:67], v100 offset:512
    ds_read_b64_tr_b16 v[68:69], v101 offset:0
    ds_read_b64_tr_b16 v[70:71], v101 offset:512
    ds_read_b64_tr_b16 v[72:73], v100 offset:2048
    ds_read_b64_tr_b16 v[74:75], v100 offset:2560
    ds_read_b64_tr_b16 v[76:77], v101 offset:2048
    ds_read_b64_tr_b16 v[78:79], v101 offset:2560
    s_waitcnt lgkmcnt(8)
    v_mfma_f32_32x32x16_bf16 v[0:15], v[80:83], v[88:91], v[0:15]
    v_mfma_f32_32x32x16_bf16 v[32:47], v[80:83], v[92:95], v[32:47]
    v_mfma_f32_32x32x16_bf16 v[16:31], v[84:87], v[88:91], v[16:31]
    v_mfma_f32_32x32x16_bf16 v[48:63], v[84:87], v[92:95], v[48:63]
    s_add_u32 m0, s40, 12288
    s_nop 0
    buffer_load_dwordx4 v96, s[8:11], s41 offen lds
    s_add_u32 m0, s40, 13312
    s_nop 0
    buffer_load_dwordx4 v97, s[8:11], s41 offen lds
    s_add_u32 m0, s40, 14336
    s_nop 0
    buffer_load_dwordx4 v98, s[12:15], s42 offen lds
    s_add_u32 m0, s40, 15360
    s_nop 0
    buffer_load_dwordx4 v99, s[12:15], s42 offen lds
    s_add_u32 s41, s41, 0x10000
    s_add_u32 s42, s42, 229376
    s_waitcnt vmcnt(8)
    ds_read_b64_tr_b16 v[80:81], v100 offset:4096
    ds_read_b64_tr_b16 v[82:83], v100 offset:4608
    ds_read_b64_tr_b16 v[84:85], v101 offset:4096
    ds_read_b64_tr_b16 v[86:87], v101 offset:4608
    ds_read_b64_tr_b16 v[88:89], v100 offset:6144
    ds_read_b64_tr_b16 v[90:91], v100 offset:6656
    ds_read_b64_tr_b16 v[92:93], v101 offset:6144
    ds_read_b64_tr_b16 v[94:95], v101 offset:6656
    s_waitcnt lgkmcnt(8)
    v_mfma_f32_32x32x16_bf16 v[0:15], v[64:67], v[72:75], v[0:15]
    v_mfma_f32_32x32x16_bf16 v[32:47], v[64:67], v[76:79], v[32:47]
    v_mfma_f32_32x32x16_bf16 v[16:31], v[68:71], v[72:75], v[16:31]
    v_mfma_f32_32x32x16_bf16 v[48:63], v[68:71], v[76:79], v[48:63]
    s_add_u32 m0, s40, 16384
    s_nop 0
    buffer_load_dwordx4 v96, s[8:11], s41 offen lds
    s_add_u32 m0, s40, 17408
    s_nop 0
    buffer_load_dwordx4 v97, s[8:11], s41 offen lds
    s_add_u32 m0, s40, 18432
    s_nop 0
    buffer_load_dwordx4 v98, s[12:15], s42 offen lds
    s_add_u32 m0, s40, 19456
    s_nop 0
    buffer_load_dwordx4 v99, s[12:15], s42 offen lds
    s_add_u32 s41, s41, 0x10000
    s_add_u32 s42, s42, 229376
    s_waitcnt vmcnt(8)
    ds_read_b64_tr_b16 v[64:65], v100 offset:8192
    ds_read_b64_tr_b16 v[66:67], v100 offset:8704
    ds_read_b64_tr_b16 v[68:69], v101 offset:8192
    ds_read_b64_tr_b16 v[70:71], v101 offset:8704
    ds_read_b64_tr_b16 v[72:73], v100 offset:10240
    ds_read_b64_tr_b16 v[74:75], v100 offset:10752
    ds_read_b64_tr_b16 v[76:77], v101 offset:10240
    ds_read_b64_tr_b16 v[78:79], v101 offset:10752
    s_waitcnt lgkmcnt(8)
    v_mfma_f32_32x32x16_bf16 v[0:15], v[80:83], v[88:91], v[0:15]
    v_mfma_f32_32x32x16_bf16 v[32:47], v[80:83], v[92:95], v[32:47]
    v_mfma_f32_32x32x16_bf16 v[16:31], v[84:87], v[88:91], v[16:31]
    v_mfma_f32_32x32x16_bf16 v[48:63], v[84:87], v[92:95], v[48:63]
    s_add_u32 m0, s40, 0
    s_nop 0
    buffer_load_dwordx4 v96, s[8:11], s41 offen lds
    s_add_u32 m0, s40, 1024
    s_nop 0
    buffer_load_dwordx4 v97, s[8:11], s41 offen lds
    s_add_u32 m0, s40, 2048
    s_nop 0
    buffer_load_dwordx4 v98, s[12:15], s42 offen lds
    s_add_u32 m0, s40, 3072
    s_nop 0
    buffer_load_dwordx4 v99, s[12:15], s42 offen lds
    s_add_u32 s41, s41, 0x10000
    s_add_u32 s42, s42, 229376
    s_waitcnt vmcnt(8)
    ds_read_b64_tr_b16 v[80:81], v100 offset:12288
    ds_read_b64_tr_b16 v[82:83], v100 offset:12800
    ds_read_b64_tr_b16 v[84:85], v101 offset:12288
    ds_read_b64_tr_b16 v[86:87], v101 offset:12800
    ds_read_b64_tr_b16 v[88:89], v100 offset:14336
    ds_read_b64_tr_b16 v[90:91], v100 offset:14848
    ds_read_b64_tr_b16 v[92:93], v101 offset:14336
    ds_read_b64_tr_b16 v[94:95], v101 offset:14848
    s_waitcnt lgkmcnt(8)
    v_mfma_f32_32x32x16_bf16 v[0:15], v[64:67], v[72:75], v[0:15]
    v_mfma_f32_32x32x16_bf16 v[32:47], v[64:67], v[76:79], v[32:47]
    v_mfma_f32_32x32x16_bf16 v[16:31], v[68:71], v[72:75], v[16:31]
    v_mfma_f32_32x32x16_bf16 v[48:63], v[68:71], v[76:79], v[48:63]
    s_add_u32 m0, s40, 4096
    s_nop 0
    buffer_load_dwordx4 v96, s[8:11], s41 offen lds
    s_add_u32 m0, s40, 5120
    s_nop 0
    buffer_load_dwordx4 v97, s[8:11], s41 offen lds
    s_add_u32 m0, s40, 6144
    s_nop 0
    buffer_load_dwordx4 v98, s[12:15], s42 offen lds
    s_add_u32 m0, s40, 7168
    s_nop 0
    buffer_load_dwordx4 v99, s[12:15], s42 offen lds
    s_add_u32 s41, s41, 0x10000
    s_add_u32 s42, s42, 229376
    s_waitcnt vmcnt(8)
    ds_read_b64_tr_b16 v[64:65], v100 offset:16384
    ds_read_b64_tr_b16 v[66:67], v100 offset:16896
    ds_read_b64_tr_b16 v[68:69], v101 offset:16384
    ds_read_b64_tr_b16 v[70:71], v101 offset:16896
    ds_read_b64_tr_b16 v[72:73], v100 offset:18432
    ds_read_b64_tr_b16 v[74:75], v100 offset:18944
    ds_read_b64_tr_b16 v[76:77], v101 offset:18432
    ds_read_b64_tr_b16 v[78:79], v101 offset:18944
    s_waitcnt lgkmcnt(8)
    v_mfma_f32_32x32x16_bf16 v[0:15], v[80:83], v[88:91], v[0:15]
    v_mfma_f32_32x32x16_bf16 v[32:47], v[80:83], v[92:95], v[32:47]
    v_mfma_f32_32x32x16_bf16 v[16:31], v[84:87], v[88:91], v[16:31]
    v_mfma_f32_32x32x16_bf16 v[48:63], v[84:87], v[92:95], v[48:63]
    s_add_u32 m0, s40, 8192
    s_nop 0
    buffer_load_dwordx4 v96, s[8:11], s41 offen lds
    s_add_u32 m0, s40, 9216
    s_nop 0
    buffer_load_dwordx4 v97, s[8:11], s41 offen lds
    s_add_u32 m0, s40, 10240
    s_nop 0
    buffer_load_dwordx4 v98, s[12:15], s42 offen lds
    s_add_u32 m0, s40, 11264
    s_nop 0
    buffer_load_dwordx4 v99, s[12:15], s42 offen lds
    s_add_u32 s41, s41, 0x10000
    s_add_u32 s42, s42, 229376
    s_waitcnt vmcnt(8)
    ds_read_b64_tr_b16 v[80:81], v100 offset:0
    ds_read_b64_tr_b16 v[82:83], v100 offset:512
    ds_read_b64_tr_b16 v[84:85], v101 offset:0
    ds_read_b64_tr_b16 v[86:87], v101 offset:512
    ds_read_b64_tr_b16 v[88:89], v100 offset:2048
    ds_read_b64_tr_b16 v[90:91], v100 offset:2560
    ds_read_b64_tr_b16 v[92:93], v101 offset:2048
    ds_read_b64_tr_b16 v[94:95], v101 offset:2560
    s_waitcnt lgkmcnt(8)
    v_mfma_f32_32x32x16_bf16 v[0:15], v[64:67], v[72:75], v[0:15]
    v_mfma_f32_32x32x16_bf16 v[32:47], v[64:67], v[76:79], v[32:47]
    v_mfma_f32_32x32x16_bf16 v[16:31], v[68:71], v[72:75], v[16:31]
    v_mfma_f32_32x32x16_bf16 v[48:63], v[68:71], v[76:79], v[48:63]
    s_add_u32 m0, s40, 12288
    s_nop 0
    buffer_load_dwordx4 v96, s[8:11], s41 offen lds
    s_add_u32 m0, s40, 13312
    s_nop 0
    buffer_load_dwordx4 v97, s[8:11], s41 offen lds
    s_add_u32 m0, s40, 14336
    s_nop 0
    buffer_load_dwordx4 v98, s[12:15], s42 offen lds
    s_add_u32 m0, s40, 15360
    s_nop 0
    buffer_load_dwordx4 v99, s[12:15], s42 offen lds
    s_add_u32 s41, s41, 0x10000
    s_add_u32 s42, s42, 229376
    s_waitcnt vmcnt(8)
    ds_read_b64_tr_b16 v[64:65], v100 offset:4096
    ds_read_b64_tr_b16 v[66:67], v100 offset:4608
    ds_read_b64_tr_b16 v[68:69], v101 offset:4096
    ds_read_b64_tr_b16 v[70:71], v101 offset:4608
    ds_read_b64_tr_b16 v[72:73], v100 offset:6144
    ds_read_b64_tr_b16 v[74:75], v100 offset:6656
    ds_read_b64_tr_b16 v[76:77], v101 offset:6144
    ds_read_b64_tr_b16 v[78:79], v101 offset:6656
    s_waitcnt lgkmcnt(8)
    v_mfma_f32_32x32x16_bf16 v[0:15], v[80:83], v[88:91], v[0:15]
    v_mfma_f32_32x32x16_bf16 v[32:47], v[80:83], v[92:95], v[32:47]
    v_mfma_f32_32x32x16_bf16 v[16:31], v[84:87], v[88:91], v[16:31]
    v_mfma_f32_32x32x16_bf16 v[48:63], v[84:87], v[92:95], v[48:63]
    s_add_u32 m0, s40, 16384
    s_nop 0
    buffer_load_dwordx4 v96, s[8:11], s41 offen lds
    s_add_u32 m0, s40, 17408
    s_nop 0
    buffer_load_dwordx4 v97, s[8:11], s41 offen lds
    s_add_u32 m0, s40, 18432
    s_nop 0
    buffer_load_dwordx4 v98, s[12:15], s42 offen lds
    s_add_u32 m0, s40, 19456
    s_nop 0
    buffer_load_dwordx4 v99, s[12:15], s42 offen lds
    s_add_u32 s41, s41, 0x10000
    s_add_u32 s42, s42, 229376
    s_waitcnt vmcnt(8)
    ds_read_b64_tr_b16 v[80:81], v100 offset:8192
    ds_read_b64_tr_b16 v[82:83], v100 offset:8704
    ds_read_b64_tr_b16 v[84:85], v101 offset:8192
    ds_read_b64_tr_b16 v[86:87], v101 offset:8704
    ds_read_b64_tr_b16 v[88:89], v100 offset:10240
    ds_read_b64_tr_b16 v[90:91], v100 offset:10752
    ds_read_b64_tr_b16 v[92:93], v101 offset:10240
    ds_read_b64_tr_b16 v[94:95], v101 offset:10752
    s_waitcnt lgkmcnt(8)
    v_mfma_f32_32x32x16_bf16 v[0:15], v[64:67], v[72:75], v[0:15]
    v_mfma_f32_32x32x16_bf16 v[32:47], v[64:67], v[76:79], v[32:47]
    v_mfma_f32_32x32x16_bf16 v[16:31], v[68:71], v[72:75], v[16:31]
    v_mfma_f32_32x32x16_bf16 v[48:63], v[68:71], v[76:79], v[48:63]
    s_add_u32 m0, s40, 0
    s_nop 0
    buffer_load_dwordx4 v96, s[8:11], s41 offen lds
    s_add_u32 m0, s40, 1024
    s_nop 0
    buffer_load_dwordx4 v97, s[8:11], s41 offen lds
    s_add_u32 m0, s40, 2048
    s_nop 0
    buffer_load_dwordx4 v98, s[12:15], s42 offen lds
    s_add_u32 m0, s40, 3072
    s_nop 0
    buffer_load_dwordx4 v99, s[12:15], s42 offen lds
    s_add_u32 s41, s41, 0x10000
    s_add_u32 s42, s42, 229376
    s_waitcnt vmcnt(8)
    ds_read_b64_tr_b16 v[64:65], v100 offset:12288
    ds_read_b64_tr_b16 v[66:67], v100 offset:12800
    ds_read_b64_tr_b16 v[68:69], v101 offset:12288
    ds_read_b64_tr_b16 v[70:71], v101 offset:12800
    ds_read_b64_tr_b16 v[72:73], v100 offset:14336
    ds_read_b64_tr_b16 v[74:75], v100 offset:14848
    ds_read_b64_tr_b16 v[76:77], v101 offset:14336
    ds_read_b64_tr_b16 v[78:79], v101 offset:14848
    s_waitcnt lgkmcnt(8)
    v_mfma_f32_32x32x16_bf16 v[0:15], v[80:83], v[88:91], v[0:15]
    v_mfma_f32_32x32x16_bf16 v[32:47], v[80:83], v[92:95], v[32:47]
    v_mfma_f32_32x32x16_bf16 v[16:31], v[84:87], v[88:91], v[16:31]
    v_mfma_f32_32x32x16_bf16 v[48:63], v[84:87], v[92:95], v[48:63]
    s_add_u32 m0, s40, 4096
    s_nop 0
    buffer_load_dwordx4 v96, s[8:11], s41 offen lds
    s_add_u32 m0, s40, 5120
    s_nop 0
    buffer_load_dwordx4 v97, s[8:11], s41 offen lds
    s_add_u32 m0, s40, 6144
    s_nop 0
    buffer_load_dwordx4 v98, s[12:15], s42 offen lds
    s_add_u32 m0, s40, 7168
    s_nop 0
    buffer_load_dwordx4 v99, s[12:15], s42 offen lds
    s_add_u32 s41, s41, 0x10000
    s_add_u32 s42, s42, 229376
    s_waitcnt vmcnt(8)
    ds_read_b64_tr_b16 v[80:81], v100 offset:16384
    ds_read_b64_tr_b16 v[82:83], v100 offset:16896
    ds_read_b64_tr_b16 v[84:85], v101 offset:16384
    ds_read_b64_tr_b16 v[86:87], v101 offset:16896
    ds_read_b64_tr_b16 v[88:89], v100 offset:18432
    ds_read_b64_tr_b16 v[90:91], v100 offset:18944
    ds_read_b64_tr_b16 v[92:93], v101 offset:18432
    ds_read_b64_tr_b16 v[94:95], v101 offset:18944
    s_waitcnt lgkmcnt(8)
    v_mfma_f32_32x32x16_bf16 v[0:15], v[64:67], v[72:75], v[0:15]
    v_mfma_f32_32x32x16_bf16 v[32:47], v[64:67], v[76:79], v[32:47]
    v_mfma_f32_32x32x16_bf16 v[16:31], v[68:71], v[72:75], v[16:31]
    v_mfma_f32_32x32x16_bf16 v[48:63], v[68:71], v[76:79], v[48:63]
    s_waitcnt vmcnt(4)
    ds_read_b64_tr_b16 v[64:65], v100 offset:0
    ds_read_b64_tr_b16 v[66:67], v100 offset:512
    ds_read_b64_tr_b16 v[68:69], v101 offset:0
    ds_read_b64_tr_b16 v[70:71], v101 offset:512
    ds_read_b64_tr_b16 v[72:73], v100 offset:2048
    ds_read_b64_tr_b16 v[74:75], v100 offset:2560
    ds_read_b64_tr_b16 v[76:77], v101 offset:2048
    ds_read_b64_tr_b16 v[78:79], v101 offset:2560
    s_waitcnt lgkmcnt(8)
    v_mfma_f32_32x32x16_bf16 v[0:15], v[80:83], v[88:91], v[0:15]
    v_mfma_f32_32x32x16_bf16 v[32:47], v[80:83], v[92:95], v[32:47]
    v_mfma_f32_32x32x16_bf16 v[16:31], v[84:87], v[88:91], v[16:31]
    v_mfma_f32_32x32x16_bf16 v[48:63], v[84:87], v[92:95], v[48:63]
    s_waitcnt vmcnt(0)
    ds_read_b64_tr_b16 v[80:81], v100 offset:4096
    ds_read_b64_tr_b16 v[82:83], v100 offset:4608
    ds_read_b64_tr_b16 v[84:85], v101 offset:4096
    ds_read_b64_tr_b16 v[86:87], v101 offset:4608
    ds_read_b64_tr_b16 v[88:89], v100 offset:6144
    ds_read_b64_tr_b16 v[90:91], v100 offset:6656
    ds_read_b64_tr_b16 v[92:93], v101 offset:6144
    ds_read_b64_tr_b16 v[94:95], v101 offset:6656
    s_waitcnt lgkmcnt(8)
    v_mfma_f32_32x32x16_bf16 v[0:15], v[64:67], v[72:75], v[0:15]
    v_mfma_f32_32x32x16_bf16 v[32:47], v[64:67], v[76:79], v[32:47]
    v_mfma_f32_32x32x16_bf16 v[16:31], v[68:71], v[72:75], v[16:31]
    v_mfma_f32_32x32x16_bf16 v[48:63], v[68:71], v[76:79], v[48:63]
    s_waitcnt lgkmcnt(0)
    v_mfma_f32_32x32x16_bf16 v[0:15], v[80:83], v[88:91], v[0:15]
    v_mfma_f32_32x32x16_bf16 v[32:47], v[80:83], v[92:95], v[32:47]
    v_mfma_f32_32x32x16_bf16 v[16:31], v[84:87], v[88:91], v[16:31]
    v_mfma_f32_32x32x16_bf16 v[48:63], v[84:87], v[92:95], v[48:63]
    s_lshr_b32 s50, s43, 1
    s_lshl_b32 s50, s50, 6
    s_add_u32 s50, s50, s49
    v_and_b32 v104, 31, v102
    v_lshlrev_b32 v105, 1, v104
    buffer_load_ushort v106, v105, s[16:19], s50 offen
    s_barrier
    s_lshl_b32 s45, s43, 14
    v_lshl_add_u32 v103, v102, 4, s45
    ds_write_b128 v103, v[0:3] offset:0
    ds_write_b128 v103, v[4:7] offset:1024
    ds_write_b128 v103, v[8:11] offset:2048
    ds_write_b128 v103, v[12:15] offset:3072
    ds_write_b128 v103, v[16:19] offset:4096
    ds_write_b128 v103, v[20:23] offset:5120
    ds_write_b128 v103, v[24:27] offset:6144
    ds_write_b128 v103, v[28:31] offset:7168
    ds_write_b128 v103, v[32:35] offset:8192
    ds_write_b128 v103, v[36:39] offset:9216
    ds_write_b128 v103, v[40:43] offset:10240
    ds_write_b128 v103, v[44:47] offset:11264
    ds_write_b128 v103, v[48:51] offset:12288
    ds_write_b128 v103, v[52:55] offset:13312
    ds_write_b128 v103, v[56:59] offset:14336
    ds_write_b128 v103, v[60:63] offset:15360
    s_waitcnt lgkmcnt(0)
    s_barrier
    s_lshl_b32 s45, s43, 12
    v_lshl_add_u32 v103, v102, 4, s45
    ds_read_b128 v[0:3], v103 offset:0
    ds_read_b128 v[4:7], v103 offset:1024
    ds_read_b128 v[8:11], v103 offset:2048
    ds_read_b128 v[12:15], v103 offset:3072
    ds_read_b128 v[16:19], v103 offset:16384
    ds_read_b128 v[20:23], v103 offset:17408
    ds_read_b128 v[24:27], v103 offset:18432
    ds_read_b128 v[28:31], v103 offset:19456
    ds_read_b128 v[32:35], v103 offset:32768
    ds_read_b128 v[36:39], v103 offset:33792
    ds_read_b128 v[40:43], v103 offset:34816
    ds_read_b128 v[44:47], v103 offset:35840
    ds_read_b128 v[48:51], v103 offset:49152
    ds_read_b128 v[52:55], v103 offset:50176
    ds_read_b128 v[56:59], v103 offset:51200
    ds_read_b128 v[60:63], v103 offset:52224
    s_waitcnt lgkmcnt(0)
    v_add_f32 v0, v0, v16
    v_add_f32 v32, v32, v48
    v_add_f32 v0, v0, v32
    v_add_f32 v1, v1, v17
    v_add_f32 v33, v33, v49
    v_add_f32 v1, v1, v33
    v_add_f32 v2, v2, v18
    v_add_f32 v34, v34, v50
    v_add_f32 v2, v2, v34
    v_add_f32 v3, v3, v19
    v_add_f32 v35, v35, v51
    v_add_f32 v3, v3, v35
    v_add_f32 v4, v4, v20
    v_add_f32 v36, v36, v52
    v_add_f32 v4, v4, v36
    v_add_f32 v5, v5, v21
    v_add_f32 v37, v37, v53
    v_add_f32 v5, v5, v37
    v_add_f32 v6, v6, v22
    v_add_f32 v38, v38, v54
    v_add_f32 v6, v6, v38
    v_add_f32 v7, v7, v23
    v_add_f32 v39, v39, v55
    v_add_f32 v7, v7, v39
    v_add_f32 v8, v8, v24
    v_add_f32 v40, v40, v56
    v_add_f32 v8, v8, v40
    v_add_f32 v9, v9, v25
    v_add_f32 v41, v41, v57
    v_add_f32 v9, v9, v41
    v_add_f32 v10, v10, v26
    v_add_f32 v42, v42, v58
    v_add_f32 v10, v10, v42
    v_add_f32 v11, v11, v27
    v_add_f32 v43, v43, v59
    v_add_f32 v11, v11, v43
    v_add_f32 v12, v12, v28
    v_add_f32 v44, v44, v60
    v_add_f32 v12, v12, v44
    v_add_f32 v13, v13, v29
    v_add_f32 v45, v45, v61
    v_add_f32 v13, v13, v45
    v_add_f32 v14, v14, v30
    v_add_f32 v46, v46, v62
    v_add_f32 v14, v14, v46
    v_add_f32 v15, v15, v31
    v_add_f32 v47, v47, v63
    v_add_f32 v15, v15, v47
    s_mov_b32 s51, 0xc0135761
    s_mov_b32 s52, 0xbdd2d3e8
    s_waitcnt vmcnt(0)
    v_lshlrev_b32 v106, 16, v106
    v_cvt_pk_bf16_f32 v16, v0, v1
    v_lshlrev_b32 v0, 16, v16
    v_and_b32 v1, 0xffff0000, v16
    v_add_f32 v0, v0, v106
    v_add_f32 v1, v1, v106
    v_cvt_pk_bf16_f32 v16, v0, v1
    v_lshlrev_b32 v0, 16, v16
    v_and_b32 v1, 0xffff0000, v16
    v_mul_f32 v17, v0, v0
    v_mov_b32 v19, s51
    v_fmac_f32 v19, s52, v17
    v_mul_f32 v17, v19, v0
    v_exp_f32 v17, v17
    s_nop 0
    v_add_f32 v17, 1.0, v17
    v_rcp_f32 v17, v17
    s_nop 0
    v_mul_f32 v0, v0, v17
    v_mul_f32 v18, v1, v1
    v_mov_b32 v19, s51
    v_fmac_f32 v19, s52, v18
    v_mul_f32 v18, v19, v1
    v_exp_f32 v18, v18
    s_nop 0
    v_add_f32 v18, 1.0, v18
    v_rcp_f32 v18, v18
    s_nop 0
    v_mul_f32 v1, v1, v18
    v_cvt_pk_bf16_f32 v20, v0, v1
    v_cvt_pk_bf16_f32 v16, v2, v3
    v_lshlrev_b32 v2, 16, v16
    v_and_b32 v3, 0xffff0000, v16
    v_add_f32 v2, v2, v106
    v_add_f32 v3, v3, v106
    v_cvt_pk_bf16_f32 v16, v2, v3
    v_lshlrev_b32 v2, 16, v16
    v_and_b32 v3, 0xffff0000, v16
    v_mul_f32 v17, v2, v2
    v_mov_b32 v19, s51
    v_fmac_f32 v19, s52, v17
    v_mul_f32 v17, v19, v2
    v_exp_f32 v17, v17
    s_nop 0
    v_add_f32 v17, 1.0, v17
    v_rcp_f32 v17, v17
    s_nop 0
    v_mul_f32 v2, v2, v17
    v_mul_f32 v18, v3, v3
    v_mov_b32 v19, s51
    v_fmac_f32 v19, s52, v18
    v_mul_f32 v18, v19, v3
    v_exp_f32 v18, v18
    s_nop 0
    v_add_f32 v18, 1.0, v18
    v_rcp_f32 v18, v18
    s_nop 0
    v_mul_f32 v3, v3, v18
    v_cvt_pk_bf16_f32 v21, v2, v3
    v_cvt_pk_bf16_f32 v16, v4, v5
    v_lshlrev_b32 v4, 16, v16
    v_and_b32 v5, 0xffff0000, v16
    v_add_f32 v4, v4, v106
    v_add_f32 v5, v5, v106
    v_cvt_pk_bf16_f32 v16, v4, v5
    v_lshlrev_b32 v4, 16, v16
    v_and_b32 v5, 0xffff0000, v16
    v_mul_f32 v17, v4, v4
    v_mov_b32 v19, s51
    v_fmac_f32 v19, s52, v17
    v_mul_f32 v17, v19, v4
    v_exp_f32 v17, v17
    s_nop 0
    v_add_f32 v17, 1.0, v17
    v_rcp_f32 v17, v17
    s_nop 0
    v_mul_f32 v4, v4, v17
    v_mul_f32 v18, v5, v5
    v_mov_b32 v19, s51
    v_fmac_f32 v19, s52, v18
    v_mul_f32 v18, v19, v5
    v_exp_f32 v18, v18
    s_nop 0
    v_add_f32 v18, 1.0, v18
    v_rcp_f32 v18, v18
    s_nop 0
    v_mul_f32 v5, v5, v18
    v_cvt_pk_bf16_f32 v22, v4, v5
    v_cvt_pk_bf16_f32 v16, v6, v7
    v_lshlrev_b32 v6, 16, v16
    v_and_b32 v7, 0xffff0000, v16
    v_add_f32 v6, v6, v106
    v_add_f32 v7, v7, v106
    v_cvt_pk_bf16_f32 v16, v6, v7
    v_lshlrev_b32 v6, 16, v16
    v_and_b32 v7, 0xffff0000, v16
    v_mul_f32 v17, v6, v6
    v_mov_b32 v19, s51
    v_fmac_f32 v19, s52, v17
    v_mul_f32 v17, v19, v6
    v_exp_f32 v17, v17
    s_nop 0
    v_add_f32 v17, 1.0, v17
    v_rcp_f32 v17, v17
    s_nop 0
    v_mul_f32 v6, v6, v17
    v_mul_f32 v18, v7, v7
    v_mov_b32 v19, s51
    v_fmac_f32 v19, s52, v18
    v_mul_f32 v18, v19, v7
    v_exp_f32 v18, v18
    s_nop 0
    v_add_f32 v18, 1.0, v18
    v_rcp_f32 v18, v18
    s_nop 0
    v_mul_f32 v7, v7, v18
    v_cvt_pk_bf16_f32 v23, v6, v7
    v_cvt_pk_bf16_f32 v16, v8, v9
    v_lshlrev_b32 v8, 16, v16
    v_and_b32 v9, 0xffff0000, v16
    v_add_f32 v8, v8, v106
    v_add_f32 v9, v9, v106
    v_cvt_pk_bf16_f32 v16, v8, v9
    v_lshlrev_b32 v8, 16, v16
    v_and_b32 v9, 0xffff0000, v16
    v_mul_f32 v17, v8, v8
    v_mov_b32 v19, s51
    v_fmac_f32 v19, s52, v17
    v_mul_f32 v17, v19, v8
    v_exp_f32 v17, v17
    s_nop 0
    v_add_f32 v17, 1.0, v17
    v_rcp_f32 v17, v17
    s_nop 0
    v_mul_f32 v8, v8, v17
    v_mul_f32 v18, v9, v9
    v_mov_b32 v19, s51
    v_fmac_f32 v19, s52, v18
    v_mul_f32 v18, v19, v9
    v_exp_f32 v18, v18
    s_nop 0
    v_add_f32 v18, 1.0, v18
    v_rcp_f32 v18, v18
    s_nop 0
    v_mul_f32 v9, v9, v18
    v_cvt_pk_bf16_f32 v24, v8, v9
    v_cvt_pk_bf16_f32 v16, v10, v11
    v_lshlrev_b32 v10, 16, v16
    v_and_b32 v11, 0xffff0000, v16
    v_add_f32 v10, v10, v106
    v_add_f32 v11, v11, v106
    v_cvt_pk_bf16_f32 v16, v10, v11
    v_lshlrev_b32 v10, 16, v16
    v_and_b32 v11, 0xffff0000, v16
    v_mul_f32 v17, v10, v10
    v_mov_b32 v19, s51
    v_fmac_f32 v19, s52, v17
    v_mul_f32 v17, v19, v10
    v_exp_f32 v17, v17
    s_nop 0
    v_add_f32 v17, 1.0, v17
    v_rcp_f32 v17, v17
    s_nop 0
    v_mul_f32 v10, v10, v17
    v_mul_f32 v18, v11, v11
    v_mov_b32 v19, s51
    v_fmac_f32 v19, s52, v18
    v_mul_f32 v18, v19, v11
    v_exp_f32 v18, v18
    s_nop 0
    v_add_f32 v18, 1.0, v18
    v_rcp_f32 v18, v18
    s_nop 0
    v_mul_f32 v11, v11, v18
    v_cvt_pk_bf16_f32 v25, v10, v11
    v_cvt_pk_bf16_f32 v16, v12, v13
    v_lshlrev_b32 v12, 16, v16
    v_and_b32 v13, 0xffff0000, v16
    v_add_f32 v12, v12, v106
    v_add_f32 v13, v13, v106
    v_cvt_pk_bf16_f32 v16, v12, v13
    v_lshlrev_b32 v12, 16, v16
    v_and_b32 v13, 0xffff0000, v16
    v_mul_f32 v17, v12, v12
    v_mov_b32 v19, s51
    v_fmac_f32 v19, s52, v17
    v_mul_f32 v17, v19, v12
    v_exp_f32 v17, v17
    s_nop 0
    v_add_f32 v17, 1.0, v17
    v_rcp_f32 v17, v17
    s_nop 0
    v_mul_f32 v12, v12, v17
    v_mul_f32 v18, v13, v13
    v_mov_b32 v19, s51
    v_fmac_f32 v19, s52, v18
    v_mul_f32 v18, v19, v13
    v_exp_f32 v18, v18
    s_nop 0
    v_add_f32 v18, 1.0, v18
    v_rcp_f32 v18, v18
    s_nop 0
    v_mul_f32 v13, v13, v18
    v_cvt_pk_bf16_f32 v26, v12, v13
    v_cvt_pk_bf16_f32 v16, v14, v15
    v_lshlrev_b32 v14, 16, v16
    v_and_b32 v15, 0xffff0000, v16
    v_add_f32 v14, v14, v106
    v_add_f32 v15, v15, v106
    v_cvt_pk_bf16_f32 v16, v14, v15
    v_lshlrev_b32 v14, 16, v16
    v_and_b32 v15, 0xffff0000, v16
    v_mul_f32 v17, v14, v14
    v_mov_b32 v19, s51
    v_fmac_f32 v19, s52, v17
    v_mul_f32 v17, v19, v14
    v_exp_f32 v17, v17
    s_nop 0
    v_add_f32 v17, 1.0, v17
    v_rcp_f32 v17, v17
    s_nop 0
    v_mul_f32 v14, v14, v17
    v_mul_f32 v18, v15, v15
    v_mov_b32 v19, s51
    v_fmac_f32 v19, s52, v18
    v_mul_f32 v18, v19, v15
    v_exp_f32 v18, v18
    s_nop 0
    v_add_f32 v18, 1.0, v18
    v_rcp_f32 v18, v18
    s_nop 0
    v_mul_f32 v15, v15, v18
    v_cvt_pk_bf16_f32 v27, v14, v15
    v_lshlrev_b32 v105, 10, v104
    v_lshrrev_b32 v106, 5, v102
    v_lshl_add_u32 v105, v106, 3, v105
    s_lshl_b32 s50, s50, 9
    s_and_b32 s51, s43, 1
    s_lshl_b32 s51, s51, 6
    s_add_u32 s51, s51, s48
    s_add_u32 s50, s50, s51
    s_add_u32 s50, s50, 0x800000
    buffer_store_dwordx2 v[20:21], v105, s[24:27], s50 offen offset:0
    buffer_store_dwordx2 v[22:23], v105, s[24:27], s50 offen offset:16
    buffer_store_dwordx2 v[24:25], v105, s[24:27], s50 offen offset:32
    buffer_store_dwordx2 v[26:27], v105, s[24:27], s50 offen offset:48
    s_branch K2_END
K2_CONV:
    s_load_dwordx2 s[4:5], s[0:1], 112
    v_lshrrev_b32 v70, 6, v0
    s_nop 0
    v_readfirstlane_b32 s43, v70
    v_and_b32 v71, 63, v0
    s_lshr_b32 s44, s43, 1
    s_and_b32 s45, s43, 1
    s_sub_u32 s46, s2, 256
    s_lshl_b32 s46, s46, 1
    s_add_u32 s46, s46, s44
    s_mul_i32 s47, s44, 33280
    s_mul_i32 s48, s44, 7680
    s_add_u32 s48, s48, 66560
    s_waitcnt lgkmcnt(0)
    s_mov_b32 s8, s4
    s_mov_b32 s9, s5
    s_mov_b32 s10, 0xc00000
    s_mov_b32 s11, 0x20000
    s_mul_i32 s49, s46, 2048
    s_add_u32 s49, s49, 0x680000
    v_lshlrev_b32 v72, 4, v71
    buffer_load_dwordx4 v[0:3], v72, s[8:11], s49 offen
    v_cmp_gt_u32 vcc, 32, v71
    s_nop 0
    s_and_saveexec_b64 s[50:51], vcc
    buffer_load_dwordx4 v[4:7], v72, s[8:11], s49 offen offset:1024
    s_mov_b64 exec, s[50:51]
    v_mov_b32 v73, 0
    buffer_load_dword v74, v73, s[8:11], s49 offen offset:1536
    s_lshl_b32 s50, s45, 11
    s_add_u32 s50, s50, s47
    v_add_u32 v73, s50, v72
    s_waitcnt vmcnt(1)
    ds_write_b128 v73, v[0:3]
    v_cmp_gt_u32 vcc, 32, v71
    s_nop 0
    s_and_saveexec_b64 s[52:53], vcc
    ds_write_b128 v73, v[4:7] offset:1024
    s_mov_b64 exec, s[52:53]
    s_waitcnt lgkmcnt(0)
    s_lshl_b32 s51, s45, 10
    v_add_u32 v8, s51, v71
    v_add_u32 v8, 0, v8
    v_sub_u32 v9, 0x7ff, v8
    v_ffbh_u32 v10, v9
    v_sub_u32 v10, 24, v10
    v_max_i32 v10, 0, v10
    v_min_u32 v10, 3, v10
    v_cmp_gt_u32 vcc, 0x100, v9
    s_nop 1
    v_cndmask_b32 v10, v10, 0, vcc
    v_lshrrev_b32 v11, v10, v9
    v_and_b32 v11, 1, v11
    v_lshlrev_b32 v12, v10, 1
    v_lshrrev_b32 v12, 1, v12
    v_add3_u32 v11, v9, v12, v11
    v_add_u32 v11, -1, v11
    v_cmp_eq_u32 vcc, 0, v10
    s_nop 1
    v_cndmask_b32 v11, v11, v9, vcc
    v_lshrrev_b32 v11, v10, v11
    v_lshlrev_b32 v11, v10, v11
    v_and_b32 v12, 7, v11
    v_bfe_u32 v13, v11, 3, 4
    v_lshrrev_b32 v14, 7, v11
    v_lshl_add_u32 v15, v14, 3, v12
    v_lshrrev_b32 v16, 1, v12
    v_lshl_add_u32 v16, v14, 2, v16
    v_add_u32 v16, 8, v16
    v_lshrrev_b32 v17, 2, v12
    v_lshl_add_u32 v17, v14, 1, v17
    v_add_u32 v17, 16, v17
    v_add_u32 v18, 24, v14
    v_cmp_gt_u32 vcc, 0x400, v11
    s_nop 1
    v_cndmask_b32 v18, v18, v17, vcc
    v_cmp_gt_u32 vcc, 0x200, v11
    s_nop 1
    v_cndmask_b32 v18, v18, v16, vcc
    v_cmp_gt_u32 vcc, 0x100, v11
    s_nop 1
    v_cndmask_b32 v18, v18, v15, vcc
    v_lshl_add_u32 v18, v18, 4, v13
    v_lshl_add_u32 v18, v18, 1, s50
    ds_read_u16 v20, v18
    v_lshrrev_b32 v12, 3, v8
    v_lshrrev_b32 v13, 2, v12
    v_add_u32 v12, v12, v13
    v_and_b32 v13, 7, v8
    v_lshlrev_b32 v13, 1, v13
    v_lshl_add_u32 v12, v12, 4, v13
    v_add_u32 v36, s48, v12
    v_add_u32 v8, s51, v71
    v_add_u32 v8, 64, v8
    v_sub_u32 v9, 0x7ff, v8
    v_ffbh_u32 v10, v9
    v_sub_u32 v10, 24, v10
    v_max_i32 v10, 0, v10
    v_min_u32 v10, 3, v10
    v_cmp_gt_u32 vcc, 0x100, v9
    s_nop 1
    v_cndmask_b32 v10, v10, 0, vcc
    v_lshrrev_b32 v11, v10, v9
    v_and_b32 v11, 1, v11
    v_lshlrev_b32 v12, v10, 1
    v_lshrrev_b32 v12, 1, v12
    v_add3_u32 v11, v9, v12, v11
    v_add_u32 v11, -1, v11
    v_cmp_eq_u32 vcc, 0, v10
    s_nop 1
    v_cndmask_b32 v11, v11, v9, vcc
    v_lshrrev_b32 v11, v10, v11
    v_lshlrev_b32 v11, v10, v11
    v_and_b32 v12, 7, v11
    v_bfe_u32 v13, v11, 3, 4
    v_lshrrev_b32 v14, 7, v11
    v_lshl_add_u32 v15, v14, 3, v12
    v_lshrrev_b32 v16, 1, v12
    v_lshl_add_u32 v16, v14, 2, v16
    v_add_u32 v16, 8, v16
    v_lshrrev_b32 v17, 2, v12
    v_lshl_add_u32 v17, v14, 1, v17
    v_add_u32 v17, 16, v17
    v_add_u32 v18, 24, v14
    v_cmp_gt_u32 vcc, 0x400, v11
    s_nop 1
    v_cndmask_b32 v18, v18, v17, vcc
    v_cmp_gt_u32 vcc, 0x200, v11
    s_nop 1
    v_cndmask_b32 v18, v18, v16, vcc
    v_cmp_gt_u32 vcc, 0x100, v11
    s_nop 1
    v_cndmask_b32 v18, v18, v15, vcc
    v_lshl_add_u32 v18, v18, 4, v13
    v_lshl_add_u32 v18, v18, 1, s50
    ds_read_u16 v21, v18
    v_lshrrev_b32 v12, 3, v8
    v_lshrrev_b32 v13, 2, v12
    v_add_u32 v12, v12, v13
    v_and_b32 v13, 7, v8
    v_lshlrev_b32 v13, 1, v13
    v_lshl_add_u32 v12, v12, 4, v13
    v_add_u32 v37, s48, v12
    v_add_u32 v8, s51, v71
    v_add_u32 v8, 128, v8
    v_sub_u32 v9, 0x7ff, v8
    v_ffbh_u32 v10, v9
    v_sub_u32 v10, 24, v10
    v_max_i32 v10, 0, v10
    v_min_u32 v10, 3, v10
    v_cmp_gt_u32 vcc, 0x100, v9
    s_nop 1
    v_cndmask_b32 v10, v10, 0, vcc
    v_lshrrev_b32 v11, v10, v9
    v_and_b32 v11, 1, v11
    v_lshlrev_b32 v12, v10, 1
    v_lshrrev_b32 v12, 1, v12
    v_add3_u32 v11, v9, v12, v11
    v_add_u32 v11, -1, v11
    v_cmp_eq_u32 vcc, 0, v10
    s_nop 1
    v_cndmask_b32 v11, v11, v9, vcc
    v_lshrrev_b32 v11, v10, v11
    v_lshlrev_b32 v11, v10, v11
    v_and_b32 v12, 7, v11
    v_bfe_u32 v13, v11, 3, 4
    v_lshrrev_b32 v14, 7, v11
    v_lshl_add_u32 v15, v14, 3, v12
    v_lshrrev_b32 v16, 1, v12
    v_lshl_add_u32 v16, v14, 2, v16
    v_add_u32 v16, 8, v16
    v_lshrrev_b32 v17, 2, v12
    v_lshl_add_u32 v17, v14, 1, v17
    v_add_u32 v17, 16, v17
    v_add_u32 v18, 24, v14
    v_cmp_gt_u32 vcc, 0x400, v11
    s_nop 1
    v_cndmask_b32 v18, v18, v17, vcc
    v_cmp_gt_u32 vcc, 0x200, v11
    s_nop 1
    v_cndmask_b32 v18, v18, v16, vcc
    v_cmp_gt_u32 vcc, 0x100, v11
    s_nop 1
    v_cndmask_b32 v18, v18, v15, vcc
    v_lshl_add_u32 v18, v18, 4, v13
    v_lshl_add_u32 v18, v18, 1, s50
    ds_read_u16 v22, v18
    v_lshrrev_b32 v12, 3, v8
    v_lshrrev_b32 v13, 2, v12
    v_add_u32 v12, v12, v13
    v_and_b32 v13, 7, v8
    v_lshlrev_b32 v13, 1, v13
    v_lshl_add_u32 v12, v12, 4, v13
    v_add_u32 v38, s48, v12
    v_add_u32 v8, s51, v71
    v_add_u32 v8, 192, v8
    v_sub_u32 v9, 0x7ff, v8
    v_ffbh_u32 v10, v9
    v_sub_u32 v10, 24, v10
    v_max_i32 v10, 0, v10
    v_min_u32 v10, 3, v10
    v_cmp_gt_u32 vcc, 0x100, v9
    s_nop 1
    v_cndmask_b32 v10, v10, 0, vcc
    v_lshrrev_b32 v11, v10, v9
    v_and_b32 v11, 1, v11
    v_lshlrev_b32 v12, v10, 1
    v_lshrrev_b32 v12, 1, v12
    v_add3_u32 v11, v9, v12, v11
    v_add_u32 v11, -1, v11
    v_cmp_eq_u32 vcc, 0, v10
    s_nop 1
    v_cndmask_b32 v11, v11, v9, vcc
    v_lshrrev_b32 v11, v10, v11
    v_lshlrev_b32 v11, v10, v11
    v_and_b32 v12, 7, v11
    v_bfe_u32 v13, v11, 3, 4
    v_lshrrev_b32 v14, 7, v11
    v_lshl_add_u32 v15, v14, 3, v12
    v_lshrrev_b32 v16, 1, v12
    v_lshl_add_u32 v16, v14, 2, v16
    v_add_u32 v16, 8, v16
    v_lshrrev_b32 v17, 2, v12
    v_lshl_add_u32 v17, v14, 1, v17
    v_add_u32 v17, 16, v17
    v_add_u32 v18, 24, v14
    v_cmp_gt_u32 vcc, 0x400, v11
    s_nop 1
    v_cndmask_b32 v18, v18, v17, vcc
    v_cmp_gt_u32 vcc, 0x200, v11
    s_nop 1
    v_cndmask_b32 v18, v18, v16, vcc
    v_cmp_gt_u32 vcc, 0x100, v11
    s_nop 1
    v_cndmask_b32 v18, v18, v15, vcc
    v_lshl_add_u32 v18, v18, 4, v13
    v_lshl_add_u32 v18, v18, 1, s50
    ds_read_u16 v23, v18
    v_lshrrev_b32 v12, 3, v8
    v_lshrrev_b32 v13, 2, v12
    v_add_u32 v12, v12, v13
    v_and_b32 v13, 7, v8
    v_lshlrev_b32 v13, 1, v13
    v_lshl_add_u32 v12, v12, 4, v13
    v_add_u32 v39, s48, v12
    v_add_u32 v8, s51, v71
    v_add_u32 v8, 256, v8
    v_sub_u32 v9, 0x7ff, v8
    v_ffbh_u32 v10, v9
    v_sub_u32 v10, 24, v10
    v_max_i32 v10, 0, v10
    v_min_u32 v10, 3, v10
    v_cmp_gt_u32 vcc, 0x100, v9
    s_nop 1
    v_cndmask_b32 v10, v10, 0, vcc
    v_lshrrev_b32 v11, v10, v9
    v_and_b32 v11, 1, v11
    v_lshlrev_b32 v12, v10, 1
    v_lshrrev_b32 v12, 1, v12
    v_add3_u32 v11, v9, v12, v11
    v_add_u32 v11, -1, v11
    v_cmp_eq_u32 vcc, 0, v10
    s_nop 1
    v_cndmask_b32 v11, v11, v9, vcc
    v_lshrrev_b32 v11, v10, v11
    v_lshlrev_b32 v11, v10, v11
    v_and_b32 v12, 7, v11
    v_bfe_u32 v13, v11, 3, 4
    v_lshrrev_b32 v14, 7, v11
    v_lshl_add_u32 v15, v14, 3, v12
    v_lshrrev_b32 v16, 1, v12
    v_lshl_add_u32 v16, v14, 2, v16
    v_add_u32 v16, 8, v16
    v_lshrrev_b32 v17, 2, v12
    v_lshl_add_u32 v17, v14, 1, v17
    v_add_u32 v17, 16, v17
    v_add_u32 v18, 24, v14
    v_cmp_gt_u32 vcc, 0x400, v11
    s_nop 1
    v_cndmask_b32 v18, v18, v17, vcc
    v_cmp_gt_u32 vcc, 0x200, v11
    s_nop 1
    v_cndmask_b32 v18, v18, v16, vcc
    v_cmp_gt_u32 vcc, 0x100, v11
    s_nop 1
    v_cndmask_b32 v18, v18, v15, vcc
    v_lshl_add_u32 v18, v18, 4, v13
    v_lshl_add_u32 v18, v18, 1, s50
    ds_read_u16 v24, v18
    v_lshrrev_b32 v12, 3, v8
    v_lshrrev_b32 v13, 2, v12
    v_add_u32 v12, v12, v13
    v_and_b32 v13, 7, v8
    v_lshlrev_b32 v13, 1, v13
    v_lshl_add_u32 v12, v12, 4, v13
    v_add_u32 v40, s48, v12
    v_add_u32 v8, s51, v71
    v_add_u32 v8, 320, v8
    v_sub_u32 v9, 0x7ff, v8
    v_ffbh_u32 v10, v9
    v_sub_u32 v10, 24, v10
    v_max_i32 v10, 0, v10
    v_min_u32 v10, 3, v10
    v_cmp_gt_u32 vcc, 0x100, v9
    s_nop 1
    v_cndmask_b32 v10, v10, 0, vcc
    v_lshrrev_b32 v11, v10, v9
    v_and_b32 v11, 1, v11
    v_lshlrev_b32 v12, v10, 1
    v_lshrrev_b32 v12, 1, v12
    v_add3_u32 v11, v9, v12, v11
    v_add_u32 v11, -1, v11
    v_cmp_eq_u32 vcc, 0, v10
    s_nop 1
    v_cndmask_b32 v11, v11, v9, vcc
    v_lshrrev_b32 v11, v10, v11
    v_lshlrev_b32 v11, v10, v11
    v_and_b32 v12, 7, v11
    v_bfe_u32 v13, v11, 3, 4
    v_lshrrev_b32 v14, 7, v11
    v_lshl_add_u32 v15, v14, 3, v12
    v_lshrrev_b32 v16, 1, v12
    v_lshl_add_u32 v16, v14, 2, v16
    v_add_u32 v16, 8, v16
    v_lshrrev_b32 v17, 2, v12
    v_lshl_add_u32 v17, v14, 1, v17
    v_add_u32 v17, 16, v17
    v_add_u32 v18, 24, v14
    v_cmp_gt_u32 vcc, 0x400, v11
    s_nop 1
    v_cndmask_b32 v18, v18, v17, vcc
    v_cmp_gt_u32 vcc, 0x200, v11
    s_nop 1
    v_cndmask_b32 v18, v18, v16, vcc
    v_cmp_gt_u32 vcc, 0x100, v11
    s_nop 1
    v_cndmask_b32 v18, v18, v15, vcc
    v_lshl_add_u32 v18, v18, 4, v13
    v_lshl_add_u32 v18, v18, 1, s50
    ds_read_u16 v25, v18
    v_lshrrev_b32 v12, 3, v8
    v_lshrrev_b32 v13, 2, v12
    v_add_u32 v12, v12, v13
    v_and_b32 v13, 7, v8
    v_lshlrev_b32 v13, 1, v13
    v_lshl_add_u32 v12, v12, 4, v13
    v_add_u32 v41, s48, v12
    v_add_u32 v8, s51, v71
    v_add_u32 v8, 384, v8
    v_sub_u32 v9, 0x7ff, v8
    v_ffbh_u32 v10, v9
    v_sub_u32 v10, 24, v10
    v_max_i32 v10, 0, v10
    v_min_u32 v10, 3, v10
    v_cmp_gt_u32 vcc, 0x100, v9
    s_nop 1
    v_cndmask_b32 v10, v10, 0, vcc
    v_lshrrev_b32 v11, v10, v9
    v_and_b32 v11, 1, v11
    v_lshlrev_b32 v12, v10, 1
    v_lshrrev_b32 v12, 1, v12
    v_add3_u32 v11, v9, v12, v11
    v_add_u32 v11, -1, v11
    v_cmp_eq_u32 vcc, 0, v10
    s_nop 1
    v_cndmask_b32 v11, v11, v9, vcc
    v_lshrrev_b32 v11, v10, v11
    v_lshlrev_b32 v11, v10, v11
    v_and_b32 v12, 7, v11
    v_bfe_u32 v13, v11, 3, 4
    v_lshrrev_b32 v14, 7, v11
    v_lshl_add_u32 v15, v14, 3, v12
    v_lshrrev_b32 v16, 1, v12
    v_lshl_add_u32 v16, v14, 2, v16
    v_add_u32 v16, 8, v16
    v_lshrrev_b32 v17, 2, v12
    v_lshl_add_u32 v17, v14, 1, v17
    v_add_u32 v17, 16, v17
    v_add_u32 v18, 24, v14
    v_cmp_gt_u32 vcc, 0x400, v11
    s_nop 1
    v_cndmask_b32 v18, v18, v17, vcc
    v_cmp_gt_u32 vcc, 0x200, v11
    s_nop 1
    v_cndmask_b32 v18, v18, v16, vcc
    v_cmp_gt_u32 vcc, 0x100, v11
    s_nop 1
    v_cndmask_b32 v18, v18, v15, vcc
    v_lshl_add_u32 v18, v18, 4, v13
    v_lshl_add_u32 v18, v18, 1, s50
    ds_read_u16 v26, v18
    v_lshrrev_b32 v12, 3, v8
    v_lshrrev_b32 v13, 2, v12
    v_add_u32 v12, v12, v13
    v_and_b32 v13, 7, v8
    v_lshlrev_b32 v13, 1, v13
    v_lshl_add_u32 v12, v12, 4, v13
    v_add_u32 v42, s48, v12
    v_add_u32 v8, s51, v71
    v_add_u32 v8, 448, v8
    v_sub_u32 v9, 0x7ff, v8
    v_ffbh_u32 v10, v9
    v_sub_u32 v10, 24, v10
    v_max_i32 v10, 0, v10
    v_min_u32 v10, 3, v10
    v_cmp_gt_u32 vcc, 0x100, v9
    s_nop 1
    v_cndmask_b32 v10, v10, 0, vcc
    v_lshrrev_b32 v11, v10, v9
    v_and_b32 v11, 1, v11
    v_lshlrev_b32 v12, v10, 1
    v_lshrrev_b32 v12, 1, v12
    v_add3_u32 v11, v9, v12, v11
    v_add_u32 v11, -1, v11
    v_cmp_eq_u32 vcc, 0, v10
    s_nop 1
    v_cndmask_b32 v11, v11, v9, vcc
    v_lshrrev_b32 v11, v10, v11
    v_lshlrev_b32 v11, v10, v11
    v_and_b32 v12, 7, v11
    v_bfe_u32 v13, v11, 3, 4
    v_lshrrev_b32 v14, 7, v11
    v_lshl_add_u32 v15, v14, 3, v12
    v_lshrrev_b32 v16, 1, v12
    v_lshl_add_u32 v16, v14, 2, v16
    v_add_u32 v16, 8, v16
    v_lshrrev_b32 v17, 2, v12
    v_lshl_add_u32 v17, v14, 1, v17
    v_add_u32 v17, 16, v17
    v_add_u32 v18, 24, v14
    v_cmp_gt_u32 vcc, 0x400, v11
    s_nop 1
    v_cndmask_b32 v18, v18, v17, vcc
    v_cmp_gt_u32 vcc, 0x200, v11
    s_nop 1
    v_cndmask_b32 v18, v18, v16, vcc
    v_cmp_gt_u32 vcc, 0x100, v11
    s_nop 1
    v_cndmask_b32 v18, v18, v15, vcc
    v_lshl_add_u32 v18, v18, 4, v13
    v_lshl_add_u32 v18, v18, 1, s50
    ds_read_u16 v27, v18
    v_lshrrev_b32 v12, 3, v8
    v_lshrrev_b32 v13, 2, v12
    v_add_u32 v12, v12, v13
    v_and_b32 v13, 7, v8
    v_lshlrev_b32 v13, 1, v13
    v_lshl_add_u32 v12, v12, 4, v13
    v_add_u32 v43, s48, v12
    v_add_u32 v8, s51, v71
    v_add_u32 v8, 512, v8
    v_sub_u32 v9, 0x7ff, v8
    v_ffbh_u32 v10, v9
    v_sub_u32 v10, 24, v10
    v_max_i32 v10, 0, v10
    v_min_u32 v10, 3, v10
    v_cmp_gt_u32 vcc, 0x100, v9
    s_nop 1
    v_cndmask_b32 v10, v10, 0, vcc
    v_lshrrev_b32 v11, v10, v9
    v_and_b32 v11, 1, v11
    v_lshlrev_b32 v12, v10, 1
    v_lshrrev_b32 v12, 1, v12
    v_add3_u32 v11, v9, v12, v11
    v_add_u32 v11, -1, v11
    v_cmp_eq_u32 vcc, 0, v10
    s_nop 1
    v_cndmask_b32 v11, v11, v9, vcc
    v_lshrrev_b32 v11, v10, v11
    v_lshlrev_b32 v11, v10, v11
    v_and_b32 v12, 7, v11
    v_bfe_u32 v13, v11, 3, 4
    v_lshrrev_b32 v14, 7, v11
    v_lshl_add_u32 v15, v14, 3, v12
    v_lshrrev_b32 v16, 1, v12
    v_lshl_add_u32 v16, v14, 2, v16
    v_add_u32 v16, 8, v16
    v_lshrrev_b32 v17, 2, v12
    v_lshl_add_u32 v17, v14, 1, v17
    v_add_u32 v17, 16, v17
    v_add_u32 v18, 24, v14
    v_cmp_gt_u32 vcc, 0x400, v11
    s_nop 1
    v_cndmask_b32 v18, v18, v17, vcc
    v_cmp_gt_u32 vcc, 0x200, v11
    s_nop 1
    v_cndmask_b32 v18, v18, v16, vcc
    v_cmp_gt_u32 vcc, 0x100, v11
    s_nop 1
    v_cndmask_b32 v18, v18, v15, vcc
    v_lshl_add_u32 v18, v18, 4, v13
    v_lshl_add_u32 v18, v18, 1, s50
    ds_read_u16 v28, v18
    v_lshrrev_b32 v12, 3, v8
    v_lshrrev_b32 v13, 2, v12
    v_add_u32 v12, v12, v13
    v_and_b32 v13, 7, v8
    v_lshlrev_b32 v13, 1, v13
    v_lshl_add_u32 v12, v12, 4, v13
    v_add_u32 v44, s48, v12
    v_add_u32 v8, s51, v71
    v_add_u32 v8, 576, v8
    v_sub_u32 v9, 0x7ff, v8
    v_ffbh_u32 v10, v9
    v_sub_u32 v10, 24, v10
    v_max_i32 v10, 0, v10
    v_min_u32 v10, 3, v10
    v_cmp_gt_u32 vcc, 0x100, v9
    s_nop 1
    v_cndmask_b32 v10, v10, 0, vcc
    v_lshrrev_b32 v11, v10, v9
    v_and_b32 v11, 1, v11
    v_lshlrev_b32 v12, v10, 1
    v_lshrrev_b32 v12, 1, v12
    v_add3_u32 v11, v9, v12, v11
    v_add_u32 v11, -1, v11
    v_cmp_eq_u32 vcc, 0, v10
    s_nop 1
    v_cndmask_b32 v11, v11, v9, vcc
    v_lshrrev_b32 v11, v10, v11
    v_lshlrev_b32 v11, v10, v11
    v_and_b32 v12, 7, v11
    v_bfe_u32 v13, v11, 3, 4
    v_lshrrev_b32 v14, 7, v11
    v_lshl_add_u32 v15, v14, 3, v12
    v_lshrrev_b32 v16, 1, v12
    v_lshl_add_u32 v16, v14, 2, v16
    v_add_u32 v16, 8, v16
    v_lshrrev_b32 v17, 2, v12
    v_lshl_add_u32 v17, v14, 1, v17
    v_add_u32 v17, 16, v17
    v_add_u32 v18, 24, v14
    v_cmp_gt_u32 vcc, 0x400, v11
    s_nop 1
    v_cndmask_b32 v18, v18, v17, vcc
    v_cmp_gt_u32 vcc, 0x200, v11
    s_nop 1
    v_cndmask_b32 v18, v18, v16, vcc
    v_cmp_gt_u32 vcc, 0x100, v11
    s_nop 1
    v_cndmask_b32 v18, v18, v15, vcc
    v_lshl_add_u32 v18, v18, 4, v13
    v_lshl_add_u32 v18, v18, 1, s50
    ds_read_u16 v29, v18
    v_lshrrev_b32 v12, 3, v8
    v_lshrrev_b32 v13, 2, v12
    v_add_u32 v12, v12, v13
    v_and_b32 v13, 7, v8
    v_lshlrev_b32 v13, 1, v13
    v_lshl_add_u32 v12, v12, 4, v13
    v_add_u32 v45, s48, v12
    v_add_u32 v8, s51, v71
    v_add_u32 v8, 640, v8
    v_sub_u32 v9, 0x7ff, v8
    v_ffbh_u32 v10, v9
    v_sub_u32 v10, 24, v10
    v_max_i32 v10, 0, v10
    v_min_u32 v10, 3, v10
    v_cmp_gt_u32 vcc, 0x100, v9
    s_nop 1
    v_cndmask_b32 v10, v10, 0, vcc
    v_lshrrev_b32 v11, v10, v9
    v_and_b32 v11, 1, v11
    v_lshlrev_b32 v12, v10, 1
    v_lshrrev_b32 v12, 1, v12
    v_add3_u32 v11, v9, v12, v11
    v_add_u32 v11, -1, v11
    v_cmp_eq_u32 vcc, 0, v10
    s_nop 1
    v_cndmask_b32 v11, v11, v9, vcc
    v_lshrrev_b32 v11, v10, v11
    v_lshlrev_b32 v11, v10, v11
    v_and_b32 v12, 7, v11
    v_bfe_u32 v13, v11, 3, 4
    v_lshrrev_b32 v14, 7, v11
    v_lshl_add_u32 v15, v14, 3, v12
    v_lshrrev_b32 v16, 1, v12
    v_lshl_add_u32 v16, v14, 2, v16
    v_add_u32 v16, 8, v16
    v_lshrrev_b32 v17, 2, v12
    v_lshl_add_u32 v17, v14, 1, v17
    v_add_u32 v17, 16, v17
    v_add_u32 v18, 24, v14
    v_cmp_gt_u32 vcc, 0x400, v11
    s_nop 1
    v_cndmask_b32 v18, v18, v17, vcc
    v_cmp_gt_u32 vcc, 0x200, v11
    s_nop 1
    v_cndmask_b32 v18, v18, v16, vcc
    v_cmp_gt_u32 vcc, 0x100, v11
    s_nop 1
    v_cndmask_b32 v18, v18, v15, vcc
    v_lshl_add_u32 v18, v18, 4, v13
    v_lshl_add_u32 v18, v18, 1, s50
    ds_read_u16 v30, v18
    v_lshrrev_b32 v12, 3, v8
    v_lshrrev_b32 v13, 2, v12
    v_add_u32 v12, v12, v13
    v_and_b32 v13, 7, v8
    v_lshlrev_b32 v13, 1, v13
    v_lshl_add_u32 v12, v12, 4, v13
    v_add_u32 v46, s48, v12
    v_add_u32 v8, s51, v71
    v_add_u32 v8, 704, v8
    v_sub_u32 v9, 0x7ff, v8
    v_ffbh_u32 v10, v9
    v_sub_u32 v10, 24, v10
    v_max_i32 v10, 0, v10
    v_min_u32 v10, 3, v10
    v_cmp_gt_u32 vcc, 0x100, v9
    s_nop 1
    v_cndmask_b32 v10, v10, 0, vcc
    v_lshrrev_b32 v11, v10, v9
    v_and_b32 v11, 1, v11
    v_lshlrev_b32 v12, v10, 1
    v_lshrrev_b32 v12, 1, v12
    v_add3_u32 v11, v9, v12, v11
    v_add_u32 v11, -1, v11
    v_cmp_eq_u32 vcc, 0, v10
    s_nop 1
    v_cndmask_b32 v11, v11, v9, vcc
    v_lshrrev_b32 v11, v10, v11
    v_lshlrev_b32 v11, v10, v11
    v_and_b32 v12, 7, v11
    v_bfe_u32 v13, v11, 3, 4
    v_lshrrev_b32 v14, 7, v11
    v_lshl_add_u32 v15, v14, 3, v12
    v_lshrrev_b32 v16, 1, v12
    v_lshl_add_u32 v16, v14, 2, v16
    v_add_u32 v16, 8, v16
    v_lshrrev_b32 v17, 2, v12
    v_lshl_add_u32 v17, v14, 1, v17
    v_add_u32 v17, 16, v17
    v_add_u32 v18, 24, v14
    v_cmp_gt_u32 vcc, 0x400, v11
    s_nop 1
    v_cndmask_b32 v18, v18, v17, vcc
    v_cmp_gt_u32 vcc, 0x200, v11
    s_nop 1
    v_cndmask_b32 v18, v18, v16, vcc
    v_cmp_gt_u32 vcc, 0x100, v11
    s_nop 1
    v_cndmask_b32 v18, v18, v15, vcc
    v_lshl_add_u32 v18, v18, 4, v13
    v_lshl_add_u32 v18, v18, 1, s50
    ds_read_u16 v31, v18
    v_lshrrev_b32 v12, 3, v8
    v_lshrrev_b32 v13, 2, v12
    v_add_u32 v12, v12, v13
    v_and_b32 v13, 7, v8
    v_lshlrev_b32 v13, 1, v13
    v_lshl_add_u32 v12, v12, 4, v13
    v_add_u32 v47, s48, v12
    v_add_u32 v8, s51, v71
    v_add_u32 v8, 768, v8
    v_sub_u32 v9, 0x7ff, v8
    v_ffbh_u32 v10, v9
    v_sub_u32 v10, 24, v10
    v_max_i32 v10, 0, v10
    v_min_u32 v10, 3, v10
    v_cmp_gt_u32 vcc, 0x100, v9
    s_nop 1
    v_cndmask_b32 v10, v10, 0, vcc
    v_lshrrev_b32 v11, v10, v9
    v_and_b32 v11, 1, v11
    v_lshlrev_b32 v12, v10, 1
    v_lshrrev_b32 v12, 1, v12
    v_add3_u32 v11, v9, v12, v11
    v_add_u32 v11, -1, v11
    v_cmp_eq_u32 vcc, 0, v10
    s_nop 1
    v_cndmask_b32 v11, v11, v9, vcc
    v_lshrrev_b32 v11, v10, v11
    v_lshlrev_b32 v11, v10, v11
    v_and_b32 v12, 7, v11
    v_bfe_u32 v13, v11, 3, 4
    v_lshrrev_b32 v14, 7, v11
    v_lshl_add_u32 v15, v14, 3, v12
    v_lshrrev_b32 v16, 1, v12
    v_lshl_add_u32 v16, v14, 2, v16
    v_add_u32 v16, 8, v16
    v_lshrrev_b32 v17, 2, v12
    v_lshl_add_u32 v17, v14, 1, v17
    v_add_u32 v17, 16, v17
    v_add_u32 v18, 24, v14
    v_cmp_gt_u32 vcc, 0x400, v11
    s_nop 1
    v_cndmask_b32 v18, v18, v17, vcc
    v_cmp_gt_u32 vcc, 0x200, v11
    s_nop 1
    v_cndmask_b32 v18, v18, v16, vcc
    v_cmp_gt_u32 vcc, 0x100, v11
    s_nop 1
    v_cndmask_b32 v18, v18, v15, vcc
    v_lshl_add_u32 v18, v18, 4, v13
    v_lshl_add_u32 v18, v18, 1, s50
    ds_read_u16 v32, v18
    v_lshrrev_b32 v12, 3, v8
    v_lshrrev_b32 v13, 2, v12
    v_add_u32 v12, v12, v13
    v_and_b32 v13, 7, v8
    v_lshlrev_b32 v13, 1, v13
    v_lshl_add_u32 v12, v12, 4, v13
    v_add_u32 v48, s48, v12
    v_add_u32 v8, s51, v71
    v_add_u32 v8, 832, v8
    v_sub_u32 v9, 0x7ff, v8
    v_ffbh_u32 v10, v9
    v_sub_u32 v10, 24, v10
    v_max_i32 v10, 0, v10
    v_min_u32 v10, 3, v10
    v_cmp_gt_u32 vcc, 0x100, v9
    s_nop 1
    v_cndmask_b32 v10, v10, 0, vcc
    v_lshrrev_b32 v11, v10, v9
    v_and_b32 v11, 1, v11
    v_lshlrev_b32 v12, v10, 1
    v_lshrrev_b32 v12, 1, v12
    v_add3_u32 v11, v9, v12, v11
    v_add_u32 v11, -1, v11
    v_cmp_eq_u32 vcc, 0, v10
    s_nop 1
    v_cndmask_b32 v11, v11, v9, vcc
    v_lshrrev_b32 v11, v10, v11
    v_lshlrev_b32 v11, v10, v11
    v_and_b32 v12, 7, v11
    v_bfe_u32 v13, v11, 3, 4
    v_lshrrev_b32 v14, 7, v11
    v_lshl_add_u32 v15, v14, 3, v12
    v_lshrrev_b32 v16, 1, v12
    v_lshl_add_u32 v16, v14, 2, v16
    v_add_u32 v16, 8, v16
    v_lshrrev_b32 v17, 2, v12
    v_lshl_add_u32 v17, v14, 1, v17
    v_add_u32 v17, 16, v17
    v_add_u32 v18, 24, v14
    v_cmp_gt_u32 vcc, 0x400, v11
    s_nop 1
    v_cndmask_b32 v18, v18, v17, vcc
    v_cmp_gt_u32 vcc, 0x200, v11
    s_nop 1
    v_cndmask_b32 v18, v18, v16, vcc
    v_cmp_gt_u32 vcc, 0x100, v11
    s_nop 1
    v_cndmask_b32 v18, v18, v15, vcc
    v_lshl_add_u32 v18, v18, 4, v13
    v_lshl_add_u32 v18, v18, 1, s50
    ds_read_u16 v33, v18
    v_lshrrev_b32 v12, 3, v8
    v_lshrrev_b32 v13, 2, v12
    v_add_u32 v12, v12, v13
    v_and_b32 v13, 7, v8
    v_lshlrev_b32 v13, 1, v13
    v_lshl_add_u32 v12, v12, 4, v13
    v_add_u32 v49, s48, v12
    v_add_u32 v8, s51, v71
    v_add_u32 v8, 896, v8
    v_sub_u32 v9, 0x7ff, v8
    v_ffbh_u32 v10, v9
    v_sub_u32 v10, 24, v10
    v_max_i32 v10, 0, v10
    v_min_u32 v10, 3, v10
    v_cmp_gt_u32 vcc, 0x100, v9
    s_nop 1
    v_cndmask_b32 v10, v10, 0, vcc
    v_lshrrev_b32 v11, v10, v9
    v_and_b32 v11, 1, v11
    v_lshlrev_b32 v12, v10, 1
    v_lshrrev_b32 v12, 1, v12
    v_add3_u32 v11, v9, v12, v11
    v_add_u32 v11, -1, v11
    v_cmp_eq_u32 vcc, 0, v10
    s_nop 1
    v_cndmask_b32 v11, v11, v9, vcc
    v_lshrrev_b32 v11, v10, v11
    v_lshlrev_b32 v11, v10, v11
    v_and_b32 v12, 7, v11
    v_bfe_u32 v13, v11, 3, 4
    v_lshrrev_b32 v14, 7, v11
    v_lshl_add_u32 v15, v14, 3, v12
    v_lshrrev_b32 v16, 1, v12
    v_lshl_add_u32 v16, v14, 2, v16
    v_add_u32 v16, 8, v16
    v_lshrrev_b32 v17, 2, v12
    v_lshl_add_u32 v17, v14, 1, v17
    v_add_u32 v17, 16, v17
    v_add_u32 v18, 24, v14
    v_cmp_gt_u32 vcc, 0x400, v11
    s_nop 1
    v_cndmask_b32 v18, v18, v17, vcc
    v_cmp_gt_u32 vcc, 0x200, v11
    s_nop 1
    v_cndmask_b32 v18, v18, v16, vcc
    v_cmp_gt_u32 vcc, 0x100, v11
    s_nop 1
    v_cndmask_b32 v18, v18, v15, vcc
    v_lshl_add_u32 v18, v18, 4, v13
    v_lshl_add_u32 v18, v18, 1, s50
    ds_read_u16 v34, v18
    v_lshrrev_b32 v12, 3, v8
    v_lshrrev_b32 v13, 2, v12
    v_add_u32 v12, v12, v13
    v_and_b32 v13, 7, v8
    v_lshlrev_b32 v13, 1, v13
    v_lshl_add_u32 v12, v12, 4, v13
    v_add_u32 v50, s48, v12
    v_add_u32 v8, s51, v71
    v_add_u32 v8, 960, v8
    v_sub_u32 v9, 0x7ff, v8
    v_ffbh_u32 v10, v9
    v_sub_u32 v10, 24, v10
    v_max_i32 v10, 0, v10
    v_min_u32 v10, 3, v10
    v_cmp_gt_u32 vcc, 0x100, v9
    s_nop 1
    v_cndmask_b32 v10, v10, 0, vcc
    v_lshrrev_b32 v11, v10, v9
    v_and_b32 v11, 1, v11
    v_lshlrev_b32 v12, v10, 1
    v_lshrrev_b32 v12, 1, v12
    v_add3_u32 v11, v9, v12, v11
    v_add_u32 v11, -1, v11
    v_cmp_eq_u32 vcc, 0, v10
    s_nop 1
    v_cndmask_b32 v11, v11, v9, vcc
    v_lshrrev_b32 v11, v10, v11
    v_lshlrev_b32 v11, v10, v11
    v_and_b32 v12, 7, v11
    v_bfe_u32 v13, v11, 3, 4
    v_lshrrev_b32 v14, 7, v11
    v_lshl_add_u32 v15, v14, 3, v12
    v_lshrrev_b32 v16, 1, v12
    v_lshl_add_u32 v16, v14, 2, v16
    v_add_u32 v16, 8, v16
    v_lshrrev_b32 v17, 2, v12
    v_lshl_add_u32 v17, v14, 1, v17
    v_add_u32 v17, 16, v17
    v_add_u32 v18, 24, v14
    v_cmp_gt_u32 vcc, 0x400, v11
    s_nop 1
    v_cndmask_b32 v18, v18, v17, vcc
    v_cmp_gt_u32 vcc, 0x200, v11
    s_nop 1
    v_cndmask_b32 v18, v18, v16, vcc
    v_cmp_gt_u32 vcc, 0x100, v11
    s_nop 1
    v_cndmask_b32 v18, v18, v15, vcc
    v_lshl_add_u32 v18, v18, 4, v13
    v_lshl_add_u32 v18, v18, 1, s50
    ds_read_u16 v35, v18
    v_lshrrev_b32 v12, 3, v8
    v_lshrrev_b32 v13, 2, v12
    v_add_u32 v12, v12, v13
    v_and_b32 v13, 7, v8
    v_lshlrev_b32 v13, 1, v13
    v_lshl_add_u32 v12, v12, 4, v13
    v_add_u32 v51, s48, v12
    s_waitcnt lgkmcnt(0)
    ds_write_b16 v36, v20
    ds_write_b16 v37, v21
    ds_write_b16 v38, v22
    ds_write_b16 v39, v23
    ds_write_b16 v40, v24
    ds_write_b16 v41, v25
    ds_write_b16 v42, v26
    ds_write_b16 v43, v27
    ds_write_b16 v44, v28
    ds_write_b16 v45, v29
    ds_write_b16 v46, v30
    ds_write_b16 v47, v31
    ds_write_b16 v48, v32
    ds_write_b16 v49, v33
    ds_write_b16 v50, v34
    ds_write_b16 v51, v35
    v_mov_b32 v20, 0
    v_mov_b32 v21, 0
    v_mov_b32 v22, 0
    v_mov_b32 v23, 0
    s_lshl_b32 s52, s45, 6
    v_add_u32 v8, s52, v71
    v_add_u32 v8, 0x100, v8
    v_cmp_gt_u32 vcc, 380, v8
    s_nop 0
    s_and_saveexec_b64 s[52:53], vcc
    v_lshrrev_b32 v9, 2, v8
    v_add_u32 v9, v9, v8
    v_lshl_add_u32 v9, v9, 4, s48
    ds_write_b128 v9, v[20:23]
    s_mov_b64 exec, s[52:53]
    s_waitcnt lgkmcnt(0)
    s_barrier
    s_mul_i32 s52, s46, 4160
    s_add_u32 s52, s52, 0x400000
    s_lshl_b32 s53, s45, 6
    v_add_u32 v8, s53, v71
    v_add_u32 v8, 0, v8
    v_cmp_gt_u32 vcc, 260, v8
    s_nop 0
    s_and_saveexec_b64 s[54:55], vcc
    v_lshlrev_b32 v9, 4, v8
    buffer_load_dwordx4 v[12:15], v9, s[8:11], s52 offen
    buffer_load_dwordx4 v[16:19], v9, s[8:11], s52 offen offset:16
    v_add_u32 v10, s47, v9
    s_waitcnt vmcnt(0)
    ds_write_b128 v10, v[12:15] offset:0
    v_alignbit_b32 v20, v13, v12, 16
    v_alignbit_b32 v21, v14, v13, 16
    v_alignbit_b32 v22, v15, v14, 16
    v_alignbit_b32 v23, v16, v15, 16
    ds_write_b128 v10, v[20:23] offset:4160
    v_mov_b32 v20, v13
    v_mov_b32 v21, v14
    v_mov_b32 v22, v15
    v_mov_b32 v23, v16
    ds_write_b128 v10, v[20:23] offset:8320
    v_alignbit_b32 v20, v14, v13, 16
    v_alignbit_b32 v21, v15, v14, 16
    v_alignbit_b32 v22, v16, v15, 16
    v_alignbit_b32 v23, v17, v16, 16
    ds_write_b128 v10, v[20:23] offset:12480
    v_mov_b32 v20, v14
    v_mov_b32 v21, v15
    v_mov_b32 v22, v16
    v_mov_b32 v23, v17
    ds_write_b128 v10, v[20:23] offset:16640
    v_alignbit_b32 v20, v15, v14, 16
    v_alignbit_b32 v21, v16, v15, 16
    v_alignbit_b32 v22, v17, v16, 16
    v_alignbit_b32 v23, v18, v17, 16
    ds_write_b128 v10, v[20:23] offset:20800
    v_mov_b32 v20, v15
    v_mov_b32 v21, v16
    v_mov_b32 v22, v17
    v_mov_b32 v23, v18
    ds_write_b128 v10, v[20:23] offset:24960
    v_alignbit_b32 v20, v16, v15, 16
    v_alignbit_b32 v21, v17, v16, 16
    v_alignbit_b32 v22, v18, v17, 16
    v_alignbit_b32 v23, v19, v18, 16
    ds_write_b128 v10, v[20:23] offset:29120
    s_mov_b64 exec, s[54:55]
    s_lshl_b32 s53, s45, 6
    v_add_u32 v8, s53, v71
    v_add_u32 v8, 128, v8
    v_cmp_gt_u32 vcc, 260, v8
    s_nop 0
    s_and_saveexec_b64 s[54:55], vcc
    v_lshlrev_b32 v9, 4, v8
    buffer_load_dwordx4 v[12:15], v9, s[8:11], s52 offen
    buffer_load_dwordx4 v[16:19], v9, s[8:11], s52 offen offset:16
    v_add_u32 v10, s47, v9
    s_waitcnt vmcnt(0)
    ds_write_b128 v10, v[12:15] offset:0
    v_alignbit_b32 v20, v13, v12, 16
    v_alignbit_b32 v21, v14, v13, 16
    v_alignbit_b32 v22, v15, v14, 16
    v_alignbit_b32 v23, v16, v15, 16
    ds_write_b128 v10, v[20:23] offset:4160
    v_mov_b32 v20, v13
    v_mov_b32 v21, v14
    v_mov_b32 v22, v15
    v_mov_b32 v23, v16
    ds_write_b128 v10, v[20:23] offset:8320
    v_alignbit_b32 v20, v14, v13, 16
    v_alignbit_b32 v21, v15, v14, 16
    v_alignbit_b32 v22, v16, v15, 16
    v_alignbit_b32 v23, v17, v16, 16
    ds_write_b128 v10, v[20:23] offset:12480
    v_mov_b32 v20, v14
    v_mov_b32 v21, v15
    v_mov_b32 v22, v16
    v_mov_b32 v23, v17
    ds_write_b128 v10, v[20:23] offset:16640
    v_alignbit_b32 v20, v15, v14, 16
    v_alignbit_b32 v21, v16, v15, 16
    v_alignbit_b32 v22, v17, v16, 16
    v_alignbit_b32 v23, v18, v17, 16
    ds_write_b128 v10, v[20:23] offset:20800
    v_mov_b32 v20, v15
    v_mov_b32 v21, v16
    v_mov_b32 v22, v17
    v_mov_b32 v23, v18
    ds_write_b128 v10, v[20:23] offset:24960
    v_alignbit_b32 v20, v16, v15, 16
    v_alignbit_b32 v21, v17, v16, 16
    v_alignbit_b32 v22, v18, v17, 16
    v_alignbit_b32 v23, v19, v18, 16
    ds_write_b128 v10, v[20:23] offset:29120
    s_mov_b64 exec, s[54:55]
    s_lshl_b32 s53, s45, 6
    v_add_u32 v8, s53, v71
    v_add_u32 v8, 256, v8
    v_cmp_gt_u32 vcc, 260, v8
    s_nop 0
    s_and_saveexec_b64 s[54:55], vcc
    v_lshlrev_b32 v9, 4, v8
    buffer_load_dwordx4 v[12:15], v9, s[8:11], s52 offen
    buffer_load_dwordx4 v[16:19], v9, s[8:11], s52 offen offset:16
    v_add_u32 v10, s47, v9
    s_waitcnt vmcnt(0)
    ds_write_b128 v10, v[12:15] offset:0
    v_alignbit_b32 v20, v13, v12, 16
    v_alignbit_b32 v21, v14, v13, 16
    v_alignbit_b32 v22, v15, v14, 16
    v_alignbit_b32 v23, v16, v15, 16
    ds_write_b128 v10, v[20:23] offset:4160
    v_mov_b32 v20, v13
    v_mov_b32 v21, v14
    v_mov_b32 v22, v15
    v_mov_b32 v23, v16
    ds_write_b128 v10, v[20:23] offset:8320
    v_alignbit_b32 v20, v14, v13, 16
    v_alignbit_b32 v21, v15, v14, 16
    v_alignbit_b32 v22, v16, v15, 16
    v_alignbit_b32 v23, v17, v16, 16
    ds_write_b128 v10, v[20:23] offset:12480
    v_mov_b32 v20, v14
    v_mov_b32 v21, v15
    v_mov_b32 v22, v16
    v_mov_b32 v23, v17
    ds_write_b128 v10, v[20:23] offset:16640
    v_alignbit_b32 v20, v15, v14, 16
    v_alignbit_b32 v21, v16, v15, 16
    v_alignbit_b32 v22, v17, v16, 16
    v_alignbit_b32 v23, v18, v17, 16
    ds_write_b128 v10, v[20:23] offset:20800
    v_mov_b32 v20, v15
    v_mov_b32 v21, v16
    v_mov_b32 v22, v17
    v_mov_b32 v23, v18
    ds_write_b128 v10, v[20:23] offset:24960
    v_alignbit_b32 v20, v16, v15, 16
    v_alignbit_b32 v21, v17, v16, 16
    v_alignbit_b32 v22, v18, v17, 16
    v_alignbit_b32 v23, v19, v18, 16
    ds_write_b128 v10, v[20:23] offset:29120
    s_mov_b64 exec, s[54:55]
    s_waitcnt lgkmcnt(0)
    s_barrier
    v_lshrrev_b32 v8, 5, v71
    v_and_b32 v9, 31, v71
    s_lshl_b32 s52, s45, 1
    v_add_u32 v10, s52, v8
    v_sub_u32 v10, 379, v10
    v_lshrrev_b32 v11, 2, v10
    v_add_u32 v10, v10, v11
    v_lshlrev_b32 v10, 4, v10
    v_mul_u32_u24 v11, 80, v9
    v_sub_u32 v10, v10, v11
    v_add_u32 v10, 0xffffec50, v10
    v_add_u32 v68, s48, v10
    v_add_u32 v10, 1, v9
    v_and_b32 v10, 7, v10
    s_lshl_b32 s52, s45, 4
    v_lshlrev_b32 v11, 3, v8
    v_add_u32 v11, s52, v11
    v_sub_u32 v12, v9, v10
    v_sub_u32 v12, v12, v11
    v_add_u32 v12, 0xfffffc19, v12
    v_mul_u32_u24 v13, 4160, v10
    v_lshl_add_u32 v12, v12, 1, v13
    v_add_u32 v69, s47, v12
    v_add_u32 v69, 0x800, v69
    ds_read_b128 v[32:35], v68 offset:5040
    ds_read_b128 v[36:39], v69 offset:4032
    ds_read_b128 v[40:43], v69 offset:1984
    ds_read_b128 v[44:47], v68 offset:4960
    ds_read_b128 v[48:51], v69 offset:3968
    ds_read_b128 v[52:55], v69 offset:1920
    ds_read_b128 v[56:59], v68 offset:4880
    ds_read_b128 v[60:63], v69 offset:3904
    ds_read_b128 v[64:67], v69 offset:1856
    s_waitcnt lgkmcnt(6)
    v_mfma_f32_32x32x16_f16 v[16:31], v[32:35], v[36:39], 0
    v_mfma_f32_32x32x16_f16 v[0:15], v[32:35], v[40:43], 0
    ds_read_b128 v[32:35], v68 offset:4800
    ds_read_b128 v[36:39], v69 offset:3840
    ds_read_b128 v[40:43], v69 offset:1792
    s_waitcnt lgkmcnt(6)
    v_mfma_f32_32x32x16_f16 v[16:31], v[44:47], v[48:51], v[16:31]
    v_mfma_f32_32x32x16_f16 v[0:15], v[44:47], v[52:55], v[0:15]
    ds_read_b128 v[44:47], v68 offset:4720
    ds_read_b128 v[48:51], v69 offset:3776
    ds_read_b128 v[52:55], v69 offset:1728
    s_waitcnt lgkmcnt(6)
    v_mfma_f32_32x32x16_f16 v[16:31], v[56:59], v[60:63], v[16:31]
    v_mfma_f32_32x32x16_f16 v[0:15], v[56:59], v[64:67], v[0:15]
    ds_read_b128 v[56:59], v68 offset:4640
    ds_read_b128 v[60:63], v69 offset:3712
    ds_read_b128 v[64:67], v69 offset:1664
    s_waitcnt lgkmcnt(6)
    v_mfma_f32_32x32x16_f16 v[16:31], v[32:35], v[36:39], v[16:31]
    v_mfma_f32_32x32x16_f16 v[0:15], v[32:35], v[40:43], v[0:15]
    ds_read_b128 v[32:35], v68 offset:4560
    ds_read_b128 v[36:39], v69 offset:3648
    ds_read_b128 v[40:43], v69 offset:1600
    s_waitcnt lgkmcnt(6)
    v_mfma_f32_32x32x16_f16 v[16:31], v[44:47], v[48:51], v[16:31]
    v_mfma_f32_32x32x16_f16 v[0:15], v[44:47], v[52:55], v[0:15]
    ds_read_b128 v[44:47], v68 offset:4480
    ds_read_b128 v[48:51], v69 offset:3584
    ds_read_b128 v[52:55], v69 offset:1536
    s_waitcnt lgkmcnt(6)
    v_mfma_f32_32x32x16_f16 v[16:31], v[56:59], v[60:63], v[16:31]
    v_mfma_f32_32x32x16_f16 v[0:15], v[56:59], v[64:67], v[0:15]
    ds_read_b128 v[56:59], v68 offset:4400
    ds_read_b128 v[60:63], v69 offset:3520
    ds_read_b128 v[64:67], v69 offset:1472
    s_waitcnt lgkmcnt(6)
    v_mfma_f32_32x32x16_f16 v[16:31], v[32:35], v[36:39], v[16:31]
    v_mfma_f32_32x32x16_f16 v[0:15], v[32:35], v[40:43], v[0:15]
    ds_read_b128 v[32:35], v68 offset:4320
    ds_read_b128 v[36:39], v69 offset:3456
    ds_read_b128 v[40:43], v69 offset:1408
    s_waitcnt lgkmcnt(6)
    v_mfma_f32_32x32x16_f16 v[16:31], v[44:47], v[48:51], v[16:31]
    v_mfma_f32_32x32x16_f16 v[0:15], v[44:47], v[52:55], v[0:15]
    ds_read_b128 v[44:47], v68 offset:4240
    ds_read_b128 v[48:51], v69 offset:3392
    ds_read_b128 v[52:55], v69 offset:1344
    s_waitcnt lgkmcnt(6)
    v_mfma_f32_32x32x16_f16 v[16:31], v[56:59], v[60:63], v[16:31]
    v_mfma_f32_32x32x16_f16 v[0:15], v[56:59], v[64:67], v[0:15]
    ds_read_b128 v[56:59], v68 offset:4160
    ds_read_b128 v[60:63], v69 offset:3328
    ds_read_b128 v[64:67], v69 offset:1280
    s_waitcnt lgkmcnt(6)
    v_mfma_f32_32x32x16_f16 v[16:31], v[32:35], v[36:39], v[16:31]
    v_mfma_f32_32x32x16_f16 v[0:15], v[32:35], v[40:43], v[0:15]
    ds_read_b128 v[32:35], v68 offset:4080
    ds_read_b128 v[36:39], v69 offset:3264
    ds_read_b128 v[40:43], v69 offset:1216
    s_waitcnt lgkmcnt(6)
    v_mfma_f32_32x32x16_f16 v[16:31], v[44:47], v[48:51], v[16:31]
    v_mfma_f32_32x32x16_f16 v[0:15], v[44:47], v[52:55], v[0:15]
    ds_read_b128 v[44:47], v68 offset:4000
    ds_read_b128 v[48:51], v69 offset:3200
    ds_read_b128 v[52:55], v69 offset:1152
    s_waitcnt lgkmcnt(6)
    v_mfma_f32_32x32x16_f16 v[16:31], v[56:59], v[60:63], v[16:31]
    v_mfma_f32_32x32x16_f16 v[0:15], v[56:59], v[64:67], v[0:15]
    ds_read_b128 v[56:59], v68 offset:3920
    ds_read_b128 v[60:63], v69 offset:3136
    ds_read_b128 v[64:67], v69 offset:1088
    s_waitcnt lgkmcnt(6)
    v_mfma_f32_32x32x16_f16 v[16:31], v[32:35], v[36:39], v[16:31]
    v_mfma_f32_32x32x16_f16 v[0:15], v[32:35], v[40:43], v[0:15]
    ds_read_b128 v[32:35], v68 offset:3840
    ds_read_b128 v[36:39], v69 offset:3072
    ds_read_b128 v[40:43], v69 offset:1024
    s_waitcnt lgkmcnt(6)
    v_mfma_f32_32x32x16_f16 v[16:31], v[44:47], v[48:51], v[16:31]
    v_mfma_f32_32x32x16_f16 v[0:15], v[44:47], v[52:55], v[0:15]
    ds_read_b128 v[44:47], v68 offset:3760
    ds_read_b128 v[48:51], v69 offset:3008
    ds_read_b128 v[52:55], v69 offset:960
    s_waitcnt lgkmcnt(6)
    v_mfma_f32_32x32x16_f16 v[16:31], v[56:59], v[60:63], v[16:31]
    v_mfma_f32_32x32x16_f16 v[0:15], v[56:59], v[64:67], v[0:15]
    ds_read_b128 v[56:59], v68 offset:3680
    ds_read_b128 v[60:63], v69 offset:2944
    ds_read_b128 v[64:67], v69 offset:896
    s_waitcnt lgkmcnt(6)
    v_mfma_f32_32x32x16_f16 v[16:31], v[32:35], v[36:39], v[16:31]
    v_mfma_f32_32x32x16_f16 v[0:15], v[32:35], v[40:43], v[0:15]
    ds_read_b128 v[32:35], v68 offset:3600
    ds_read_b128 v[36:39], v69 offset:2880
    ds_read_b128 v[40:43], v69 offset:832
    s_waitcnt lgkmcnt(6)
    v_mfma_f32_32x32x16_f16 v[16:31], v[44:47], v[48:51], v[16:31]
    v_mfma_f32_32x32x16_f16 v[0:15], v[44:47], v[52:55], v[0:15]
    ds_read_b128 v[44:47], v68 offset:3520
    ds_read_b128 v[48:51], v69 offset:2816
    ds_read_b128 v[52:55], v69 offset:768
    s_waitcnt lgkmcnt(6)
    v_mfma_f32_32x32x16_f16 v[16:31], v[56:59], v[60:63], v[16:31]
    v_mfma_f32_32x32x16_f16 v[0:15], v[56:59], v[64:67], v[0:15]
    ds_read_b128 v[56:59], v68 offset:3440
    ds_read_b128 v[60:63], v69 offset:2752
    ds_read_b128 v[64:67], v69 offset:704
    s_waitcnt lgkmcnt(6)
    v_mfma_f32_32x32x16_f16 v[16:31], v[32:35], v[36:39], v[16:31]
    v_mfma_f32_32x32x16_f16 v[0:15], v[32:35], v[40:43], v[0:15]
    ds_read_b128 v[32:35], v68 offset:3360
    ds_read_b128 v[36:39], v69 offset:2688
    ds_read_b128 v[40:43], v69 offset:640
    s_waitcnt lgkmcnt(6)
    v_mfma_f32_32x32x16_f16 v[16:31], v[44:47], v[48:51], v[16:31]
    v_mfma_f32_32x32x16_f16 v[0:15], v[44:47], v[52:55], v[0:15]
    ds_read_b128 v[44:47], v68 offset:3280
    ds_read_b128 v[48:51], v69 offset:2624
    ds_read_b128 v[52:55], v69 offset:576
    s_waitcnt lgkmcnt(6)
    v_mfma_f32_32x32x16_f16 v[16:31], v[56:59], v[60:63], v[16:31]
    v_mfma_f32_32x32x16_f16 v[0:15], v[56:59], v[64:67], v[0:15]
    ds_read_b128 v[56:59], v68 offset:3200
    ds_read_b128 v[60:63], v69 offset:2560
    ds_read_b128 v[64:67], v69 offset:512
    s_waitcnt lgkmcnt(6)
    v_mfma_f32_32x32x16_f16 v[16:31], v[32:35], v[36:39], v[16:31]
    v_mfma_f32_32x32x16_f16 v[0:15], v[32:35], v[40:43], v[0:15]
    ds_read_b128 v[32:35], v68 offset:3120
    ds_read_b128 v[36:39], v69 offset:2496
    ds_read_b128 v[40:43], v69 offset:448
    s_waitcnt lgkmcnt(6)
    v_mfma_f32_32x32x16_f16 v[16:31], v[44:47], v[48:51], v[16:31]
    v_mfma_f32_32x32x16_f16 v[0:15], v[44:47], v[52:55], v[0:15]
    ds_read_b128 v[44:47], v68 offset:3040
    ds_read_b128 v[48:51], v69 offset:2432
    ds_read_b128 v[52:55], v69 offset:384
    s_waitcnt lgkmcnt(6)
    v_mfma_f32_32x32x16_f16 v[16:31], v[56:59], v[60:63], v[16:31]
    v_mfma_f32_32x32x16_f16 v[0:15], v[56:59], v[64:67], v[0:15]
    ds_read_b128 v[56:59], v68 offset:2960
    ds_read_b128 v[60:63], v69 offset:2368
    ds_read_b128 v[64:67], v69 offset:320
    s_waitcnt lgkmcnt(6)
    v_mfma_f32_32x32x16_f16 v[16:31], v[32:35], v[36:39], v[16:31]
    v_mfma_f32_32x32x16_f16 v[0:15], v[32:35], v[40:43], v[0:15]
    ds_read_b128 v[32:35], v68 offset:2880
    ds_read_b128 v[36:39], v69 offset:2304
    ds_read_b128 v[40:43], v69 offset:256
    s_waitcnt lgkmcnt(6)
    v_mfma_f32_32x32x16_f16 v[16:31], v[44:47], v[48:51], v[16:31]
    v_mfma_f32_32x32x16_f16 v[0:15], v[44:47], v[52:55], v[0:15]
    ds_read_b128 v[44:47], v68 offset:2800
    ds_read_b128 v[48:51], v69 offset:2240
    ds_read_b128 v[52:55], v69 offset:192
    s_waitcnt lgkmcnt(6)
    v_mfma_f32_32x32x16_f16 v[16:31], v[56:59], v[60:63], v[16:31]
    v_mfma_f32_32x32x16_f16 v[0:15], v[56:59], v[64:67], v[0:15]
    ds_read_b128 v[56:59], v68 offset:2720
    ds_read_b128 v[60:63], v69 offset:2176
    ds_read_b128 v[64:67], v69 offset:128
    s_waitcnt lgkmcnt(6)
    v_mfma_f32_32x32x16_f16 v[16:31], v[32:35], v[36:39], v[16:31]
    v_mfma_f32_32x32x16_f16 v[0:15], v[32:35], v[40:43], v[0:15]
    ds_read_b128 v[32:35], v68 offset:2640
    ds_read_b128 v[36:39], v69 offset:2112
    ds_read_b128 v[40:43], v69 offset:64
    s_waitcnt lgkmcnt(6)
    v_mfma_f32_32x32x16_f16 v[16:31], v[44:47], v[48:51], v[16:31]
    v_mfma_f32_32x32x16_f16 v[0:15], v[44:47], v[52:55], v[0:15]
    ds_read_b128 v[44:47], v68 offset:2560
    ds_read_b128 v[48:51], v69 offset:2048
    ds_read_b128 v[52:55], v69 offset:0
    s_waitcnt lgkmcnt(6)
    v_mfma_f32_32x32x16_f16 v[16:31], v[56:59], v[60:63], v[16:31]
    v_mfma_f32_32x32x16_f16 v[0:15], v[56:59], v[64:67], v[0:15]
    ds_read_b128 v[56:59], v68 offset:2480
    ds_read_b128 v[60:63], v69 offset:1984
    s_waitcnt lgkmcnt(5)
    v_mfma_f32_32x32x16_f16 v[16:31], v[32:35], v[36:39], v[16:31]
    v_mfma_f32_32x32x16_f16 v[0:15], v[32:35], v[40:43], v[0:15]
    ds_read_b128 v[32:35], v68 offset:2400
    ds_read_b128 v[36:39], v69 offset:1920
    s_waitcnt lgkmcnt(4)
    v_mfma_f32_32x32x16_f16 v[16:31], v[44:47], v[48:51], v[16:31]
    v_mfma_f32_32x32x16_f16 v[0:15], v[44:47], v[52:55], v[0:15]
    ds_read_b128 v[44:47], v68 offset:2320
    ds_read_b128 v[48:51], v69 offset:1856
    s_waitcnt lgkmcnt(4)
    v_mfma_f32_32x32x16_f16 v[16:31], v[56:59], v[60:63], v[16:31]
    ds_read_b128 v[56:59], v68 offset:2240
    ds_read_b128 v[60:63], v69 offset:1792
    s_waitcnt lgkmcnt(4)
    v_mfma_f32_32x32x16_f16 v[16:31], v[32:35], v[36:39], v[16:31]
    ds_read_b128 v[32:35], v68 offset:2160
    ds_read_b128 v[36:39], v69 offset:1728
    s_waitcnt lgkmcnt(4)
    v_mfma_f32_32x32x16_f16 v[16:31], v[44:47], v[48:51], v[16:31]
    ds_read_b128 v[44:47], v68 offset:2080
    ds_read_b128 v[48:51], v69 offset:1664
    s_waitcnt lgkmcnt(4)
    v_mfma_f32_32x32x16_f16 v[16:31], v[56:59], v[60:63], v[16:31]
    ds_read_b128 v[56:59], v68 offset:2000
    ds_read_b128 v[60:63], v69 offset:1600
    s_waitcnt lgkmcnt(4)
    v_mfma_f32_32x32x16_f16 v[16:31], v[32:35], v[36:39], v[16:31]
    ds_read_b128 v[32:35], v68 offset:1920
    ds_read_b128 v[36:39], v69 offset:1536
    s_waitcnt lgkmcnt(4)
    v_mfma_f32_32x32x16_f16 v[16:31], v[44:47], v[48:51], v[16:31]
    ds_read_b128 v[44:47], v68 offset:1840
    ds_read_b128 v[48:51], v69 offset:1472
    s_waitcnt lgkmcnt(4)
    v_mfma_f32_32x32x16_f16 v[16:31], v[56:59], v[60:63], v[16:31]
    ds_read_b128 v[56:59], v68 offset:1760
    ds_read_b128 v[60:63], v69 offset:1408
    s_waitcnt lgkmcnt(4)
    v_mfma_f32_32x32x16_f16 v[16:31], v[32:35], v[36:39], v[16:31]
    ds_read_b128 v[32:35], v68 offset:1680
    ds_read_b128 v[36:39], v69 offset:1344
    s_waitcnt lgkmcnt(4)
    v_mfma_f32_32x32x16_f16 v[16:31], v[44:47], v[48:51], v[16:31]
    ds_read_b128 v[44:47], v68 offset:1600
    ds_read_b128 v[48:51], v69 offset:1280
    s_waitcnt lgkmcnt(4)
    v_mfma_f32_32x32x16_f16 v[16:31], v[56:59], v[60:63], v[16:31]
    ds_read_b128 v[56:59], v68 offset:1520
    ds_read_b128 v[60:63], v69 offset:1216
    s_waitcnt lgkmcnt(4)
    v_mfma_f32_32x32x16_f16 v[16:31], v[32:35], v[36:39], v[16:31]
    ds_read_b128 v[32:35], v68 offset:1440
    ds_read_b128 v[36:39], v69 offset:1152
    s_waitcnt lgkmcnt(4)
    v_mfma_f32_32x32x16_f16 v[16:31], v[44:47], v[48:51], v[16:31]
    ds_read_b128 v[44:47], v68 offset:1360
    ds_read_b128 v[48:51], v69 offset:1088
    s_waitcnt lgkmcnt(4)
    v_mfma_f32_32x32x16_f16 v[16:31], v[56:59], v[60:63], v[16:31]
    ds_read_b128 v[56:59], v68 offset:1280
    ds_read_b128 v[60:63], v69 offset:1024
    s_waitcnt lgkmcnt(4)
    v_mfma_f32_32x32x16_f16 v[16:31], v[32:35], v[36:39], v[16:31]
    ds_read_b128 v[32:35], v68 offset:1200
    ds_read_b128 v[36:39], v69 offset:960
    s_waitcnt lgkmcnt(4)
    v_mfma_f32_32x32x16_f16 v[16:31], v[44:47], v[48:51], v[16:31]
    ds_read_b128 v[44:47], v68 offset:1120
    ds_read_b128 v[48:51], v69 offset:896
    s_waitcnt lgkmcnt(4)
    v_mfma_f32_32x32x16_f16 v[16:31], v[56:59], v[60:63], v[16:31]
    ds_read_b128 v[56:59], v68 offset:1040
    ds_read_b128 v[60:63], v69 offset:832
    s_waitcnt lgkmcnt(4)
    v_mfma_f32_32x32x16_f16 v[16:31], v[32:35], v[36:39], v[16:31]
    ds_read_b128 v[32:35], v68 offset:960
    ds_read_b128 v[36:39], v69 offset:768
    s_waitcnt lgkmcnt(4)
    v_mfma_f32_32x32x16_f16 v[16:31], v[44:47], v[48:51], v[16:31]
    ds_read_b128 v[44:47], v68 offset:880
    ds_read_b128 v[48:51], v69 offset:704
    s_waitcnt lgkmcnt(4)
    v_mfma_f32_32x32x16_f16 v[16:31], v[56:59], v[60:63], v[16:31]
    ds_read_b128 v[56:59], v68 offset:800
    ds_read_b128 v[60:63], v69 offset:640
    s_waitcnt lgkmcnt(4)
    v_mfma_f32_32x32x16_f16 v[16:31], v[32:35], v[36:39], v[16:31]
    ds_read_b128 v[32:35], v68 offset:720
    ds_read_b128 v[36:39], v69 offset:576
    s_waitcnt lgkmcnt(4)
    v_mfma_f32_32x32x16_f16 v[16:31], v[44:47], v[48:51], v[16:31]
    ds_read_b128 v[44:47], v68 offset:640
    ds_read_b128 v[48:51], v69 offset:512
    s_waitcnt lgkmcnt(4)
    v_mfma_f32_32x32x16_f16 v[16:31], v[56:59], v[60:63], v[16:31]
    ds_read_b128 v[56:59], v68 offset:560
    ds_read_b128 v[60:63], v69 offset:448
    s_waitcnt lgkmcnt(4)
    v_mfma_f32_32x32x16_f16 v[16:31], v[32:35], v[36:39], v[16:31]
    ds_read_b128 v[32:35], v68 offset:480
    ds_read_b128 v[36:39], v69 offset:384
    s_waitcnt lgkmcnt(4)
    v_mfma_f32_32x32x16_f16 v[16:31], v[44:47], v[48:51], v[16:31]
    ds_read_b128 v[44:47], v68 offset:400
    ds_read_b128 v[48:51], v69 offset:320
    s_waitcnt lgkmcnt(4)
    v_mfma_f32_32x32x16_f16 v[16:31], v[56:59], v[60:63], v[16:31]
    ds_read_b128 v[56:59], v68 offset:320
    ds_read_b128 v[60:63], v69 offset:256
    s_waitcnt lgkmcnt(4)
    v_mfma_f32_32x32x16_f16 v[16:31], v[32:35], v[36:39], v[16:31]
    ds_read_b128 v[32:35], v68 offset:240
    ds_read_b128 v[36:39], v69 offset:192
    s_waitcnt lgkmcnt(4)
    v_mfma_f32_32x32x16_f16 v[16:31], v[44:47], v[48:51], v[16:31]
    ds_read_b128 v[44:47], v68 offset:160
    ds_read_b128 v[48:51], v69 offset:128
    s_waitcnt lgkmcnt(4)
    v_mfma_f32_32x32x16_f16 v[16:31], v[56:59], v[60:63], v[16:31]
    ds_read_b128 v[56:59], v68 offset:80
    ds_read_b128 v[60:63], v69 offset:64
    s_waitcnt lgkmcnt(4)
    v_mfma_f32_32x32x16_f16 v[16:31], v[32:35], v[36:39], v[16:31]
    ds_read_b128 v[32:35], v68 offset:0
    ds_read_b128 v[36:39], v69 offset:0
    s_waitcnt lgkmcnt(4)
    v_mfma_f32_32x32x16_f16 v[16:31], v[44:47], v[48:51], v[16:31]
    s_waitcnt lgkmcnt(2)
    v_mfma_f32_32x32x16_f16 v[16:31], v[56:59], v[60:63], v[16:31]
    s_waitcnt lgkmcnt(0)
    v_mfma_f32_32x32x16_f16 v[16:31], v[32:35], v[36:39], v[16:31]
    s_barrier
    s_nop 7
    s_nop 7
    s_lshl_b32 s52, s43, 12
    v_lshl_add_u32 v70, v71, 4, s52
    s_cmp_eq_u32 s45, 0
    s_cbranch_scc1 K2C_W1
    ds_write_b128 v70, v[0:3] offset:0
    ds_write_b128 v70, v[4:7] offset:1024
    ds_write_b128 v70, v[8:11] offset:2048
    ds_write_b128 v70, v[12:15] offset:3072
    s_branch K2C_W2
K2C_W1:
    ds_write_b128 v70, v[16:19] offset:0
    ds_write_b128 v70, v[20:23] offset:1024
    ds_write_b128 v70, v[24:27] offset:2048
    ds_write_b128 v70, v[28:31] offset:3072
K2C_W2:
    s_waitcnt lgkmcnt(0)
    s_barrier
    s_xor_b32 s52, s43, 1
    s_lshl_b32 s52, s52, 12
    v_lshl_add_u32 v70, v71, 4, s52
    ds_read_b128 v[32:35], v70 offset:0
    ds_read_b128 v[36:39], v70 offset:1024
    ds_read_b128 v[40:43], v70 offset:2048
    ds_read_b128 v[44:47], v70 offset:3072
    s_cmp_eq_u32 s45, 0
    s_cbranch_scc1 K2C_F0
    v_mov_b32 v0, v16
    v_mov_b32 v1, v17
    v_mov_b32 v2, v18
    v_mov_b32 v3, v19
    v_mov_b32 v4, v20
    v_mov_b32 v5, v21
    v_mov_b32 v6, v22
    v_mov_b32 v7, v23
    v_mov_b32 v8, v24
    v_mov_b32 v9, v25
    v_mov_b32 v10, v26
    v_mov_b32 v11, v27
    v_mov_b32 v12, v28
    v_mov_b32 v13, v29
    v_mov_b32 v14, v30
    v_mov_b32 v15, v31
K2C_F0:
    s_waitcnt lgkmcnt(0) vmcnt(0)
    v_add_f32 v0, v0, v32
    v_add_f32 v1, v1, v33
    v_add_f32 v2, v2, v34
    v_add_f32 v3, v3, v35
    v_add_f32 v4, v4, v36
    v_add_f32 v5, v5, v37
    v_add_f32 v6, v6, v38
    v_add_f32 v7, v7, v39
    v_add_f32 v8, v8, v40
    v_add_f32 v9, v9, v41
    v_add_f32 v10, v10, v42
    v_add_f32 v11, v11, v43
    v_add_f32 v12, v12, v44
    v_add_f32 v13, v13, v45
    v_add_f32 v14, v14, v46
    v_add_f32 v15, v15, v47
    v_mul_f32 v0, v0, v74
    v_mul_f32 v1, v1, v74
    v_mul_f32 v2, v2, v74
    v_mul_f32 v3, v3, v74
    v_mul_f32 v4, v4, v74
    v_mul_f32 v5, v5, v74
    v_mul_f32 v6, v6, v74
    v_mul_f32 v7, v7, v74
    v_mul_f32 v8, v8, v74
    v_mul_f32 v9, v9, v74
    v_mul_f32 v10, v10, v74
    v_mul_f32 v11, v11, v74
    v_mul_f32 v12, v12, v74
    v_mul_f32 v13, v13, v74
    v_mul_f32 v14, v14, v74
    v_mul_f32 v15, v15, v74
    v_cvt_pk_bf16_f32 v0, v0, v0
    v_cvt_pk_bf16_f32 v1, v1, v1
    v_cvt_pk_bf16_f32 v2, v2, v2
    v_cvt_pk_bf16_f32 v3, v3, v3
    v_cvt_pk_bf16_f32 v4, v4, v4
    v_cvt_pk_bf16_f32 v5, v5, v5
    v_cvt_pk_bf16_f32 v6, v6, v6
    v_cvt_pk_bf16_f32 v7, v7, v7
    v_cvt_pk_bf16_f32 v8, v8, v8
    v_cvt_pk_bf16_f32 v9, v9, v9
    v_cvt_pk_bf16_f32 v10, v10, v10
    v_cvt_pk_bf16_f32 v11, v11, v11
    v_cvt_pk_bf16_f32 v12, v12, v12
    v_cvt_pk_bf16_f32 v13, v13, v13
    v_cvt_pk_bf16_f32 v14, v14, v14
    v_cvt_pk_bf16_f32 v15, v15, v15
    v_lshrrev_b32 v72, 5, v71
    v_and_b32 v73, 31, v71
    v_lshl_add_u32 v70, v72, 7, v73
    v_lshlrev_b32 v70, 1, v70
    s_lshl_b32 s52, s46, 12
    s_lshl_b32 s53, s45, 11
    s_add_u32 s52, s52, s53
    s_add_u32 s52, s52, 0xa00000
    buffer_store_short v0, v70, s[8:11], s52 offen offset:0
    buffer_store_short v1, v70, s[8:11], s52 offen offset:64
    buffer_store_short v2, v70, s[8:11], s52 offen offset:128
    buffer_store_short v3, v70, s[8:11], s52 offen offset:192
    buffer_store_short v4, v70, s[8:11], s52 offen offset:512
    buffer_store_short v5, v70, s[8:11], s52 offen offset:576
    buffer_store_short v6, v70, s[8:11], s52 offen offset:640
    buffer_store_short v7, v70, s[8:11], s52 offen offset:704
    buffer_store_short v8, v70, s[8:11], s52 offen offset:1024
    buffer_store_short v9, v70, s[8:11], s52 offen offset:1088
    buffer_store_short v10, v70, s[8:11], s52 offen offset:1152
    buffer_store_short v11, v70, s[8:11], s52 offen offset:1216
    buffer_store_short v12, v70, s[8:11], s52 offen offset:1536
    buffer_store_short v13, v70, s[8:11], s52 offen offset:1600
    buffer_store_short v14, v70, s[8:11], s52 offen offset:1664
    buffer_store_short v15, v70, s[8:11], s52 offen offset:1728
K2_END:
    s_endpgm
.section .rodata,"a"
.p2align 6
.amdhsa_kernel k2_mid_kernel
  .amdhsa_next_free_vgpr 128
  .amdhsa_next_free_sgpr 102
  .amdhsa_accum_offset 128
  .amdhsa_group_segment_fixed_size 0
  .amdhsa_kernarg_size 120
  .amdhsa_user_sgpr_count 2
  .amdhsa_user_sgpr_kernarg_segment_ptr 1
  .amdhsa_system_sgpr_workgroup_id_x 1
.end_amdhsa_kernel
.text
.globl k3_out_kernel
.p2align 8
.type k3_out_kernel,@function
k3_out_kernel:
    s_cmp_ge_u32 s2, 256
    s_cbranch_scc1 K3_END
    s_and_b32 s46, s2, 7
    s_lshr_b32 s47, s2, 3
    s_lshr_b32 s48, s47, 3
    s_lshl_b32 s48, s48, 3
    s_add_u32 s46, s46, s48
    s_and_b32 s47, s47, 7
    s_load_dwordx2 s[4:5], s[0:1], 112
    s_load_dwordx2 s[6:7], s[0:1], 80
    s_load_dwordx2 s[20:21], s[0:1], 88
    s_load_dwordx2 s[22:23], s[0:1], 0
    s_load_dwordx2 s[54:55], s[0:1], 48
    s_load_dwordx2 s[56:57], s[0:1], 96
    s_lshl_b32 s48, s47, 7
    s_lshl_b32 s49, s46, 7
    s_waitcnt lgkmcnt(0)
    s_add_u32 s8, s4, 0x800000
    s_addc_u32 s9, s5, 0
    s_mov_b32 s10, 0x1c0000
    s_mov_b32 s11, 0x20000
    s_mov_b32 s12, s6
    s_mov_b32 s13, s7
    s_mov_b32 s14, 0x700000
    s_mov_b32 s15, 0x20000
    s_mov_b32 s16, s20
    s_mov_b32 s17, s21
    s_mov_b32 s18, 0x1000
    s_mov_b32 s19, 0x20000
    s_mov_b32 s24, s4
    s_mov_b32 s25, s5
    s_mov_b32 s26, 0xc00000
    s_mov_b32 s27, 0x20000
    s_mov_b32 s28, s22
    s_mov_b32 s29, s23
    s_mov_b32 s30, 0x200000
    s_mov_b32 s31, 0x20000
    s_mov_b32 s32, s54
    s_mov_b32 s33, s55
    s_mov_b32 s34, 0x400
    s_mov_b32 s35, 0x20000
    s_mov_b32 s36, s56
    s_mov_b32 s37, s57
    s_mov_b32 s38, 0x200000
    s_mov_b32 s39, 0x20000
    v_lshrrev_b32 v102, 6, v0
    s_nop 0
    v_readfirstlane_b32 s43, v102
    v_and_b32 v102, 63, v0
    s_mul_i32 s40, s43, 20480
    v_lshrrev_b32 v103, 3, v102
    v_bfe_u32 v104, v102, 4, 1
    v_lshlrev_b32 v104, 2, v104
    v_and_b32 v105, 7, v102
    v_xor_b32 v105, v105, v104
    v_lshlrev_b32 v105, 4, v105
    s_lshl_b32 s44, s43, 4
    v_add_u32 v103, s44, v103
    v_lshlrev_b32 v96, 10, v103
    v_add3_u32 v96, v96, v105, s48
    v_add_u32 v97, 0x2000, v96
    v_mul_u32_u24 v98, 4096, v103
    v_add3_u32 v98, v98, v105, s49
    v_add_u32 v99, 32768, v98
    v_lshrrev_b32 v103, 5, v102
    v_lshlrev_b32 v103, 3, v103
    v_bfe_u32 v104, v102, 2, 2
    v_add_u32 v103, v103, v104
    v_lshlrev_b32 v103, 7, v103
    v_bfe_u32 v104, v102, 4, 1
    v_lshlrev_b32 v104, 5, v104
    v_add_u32 v103, v103, v104
    v_and_b32 v104, 3, v102
    v_lshlrev_b32 v104, 3, v104
    v_add_u32 v103, v103, v104
    v_bfe_u32 v104, v102, 3, 1
    v_lshlrev_b32 v104, 6, v104
    v_add_u32 v103, v103, v104
    v_add_u32 v100, s40, v103
    v_xor_b32 v101, 64, v100
    s_mov_b32 s41, 0
    s_mov_b32 s42, 0
    s_add_u32 m0, s40, 0
    s_nop 0
    buffer_load_dwordx4 v96, s[8:11], s41 offen lds
    s_add_u32 m0, s40, 1024
    s_nop 0
    buffer_load_dwordx4 v97, s[8:11], s41 offen lds
    s_add_u32 m0, s40, 2048
    s_nop 0
    buffer_load_dwordx4 v98, s[12:15], s42 offen lds
    s_add_u32 m0, s40, 3072
    s_nop 0
    buffer_load_dwordx4 v99, s[12:15], s42 offen lds
    s_add_u32 s41, s41, 0x10000
    s_add_u32 s42, s42, 262144
    s_add_u32 m0, s40, 4096
    s_nop 0
    buffer_load_dwordx4 v96, s[8:11], s41 offen lds
    s_add_u32 m0, s40, 5120
    s_nop 0
    buffer_load_dwordx4 v97, s[8:11], s41 offen lds
    s_add_u32 m0, s40, 6144
    s_nop 0
    buffer_load_dwordx4 v98, s[12:15], s42 offen lds
    s_add_u32 m0, s40, 7168
    s_nop 0
    buffer_load_dwordx4 v99, s[12:15], s42 offen lds
    s_add_u32 s41, s41, 0x10000
    s_add_u32 s42, s42, 262144
    s_add_u32 m0, s40, 8192
    s_nop 0
    buffer_load_dwordx4 v96, s[8:11], s41 offen lds
    s_add_u32 m0, s40, 9216
    s_nop 0
    buffer_load_dwordx4 v97, s[8:11], s41 offen lds
    s_add_u32 m0, s40, 10240
    s_nop 0
    buffer_load_dwordx4 v98, s[12:15], s42 offen lds
    s_add_u32 m0, s40, 11264
    s_nop 0
    buffer_load_dwordx4 v99, s[12:15], s42 offen lds
    s_add_u32 s41, s41, 0x10000
    s_add_u32 s42, s42, 262144
    s_add_u32 m0, s40, 12288
    s_nop 0
    buffer_load_dwordx4 v96, s[8:11], s41 offen lds
    s_add_u32 m0, s40, 13312
    s_nop 0
    buffer_load_dwordx4 v97, s[8:11], s41 offen lds
    s_add_u32 m0, s40, 14336
    s_nop 0
    buffer_load_dwordx4 v98, s[12:15], s42 offen lds
    s_add_u32 m0, s40, 15360
    s_nop 0
    buffer_load_dwordx4 v99, s[12:15], s42 offen lds
    s_add_u32 s41, s41, 0x10000
    s_add_u32 s42, s42, 262144
    s_waitcnt vmcnt(12)
    ds_read_b64_tr_b16 v[64:65], v100 offset:0
    ds_read_b64_tr_b16 v[66:67], v100 offset:512
    ds_read_b64_tr_b16 v[68:69], v101 offset:0
    ds_read_b64_tr_b16 v[70:71], v101 offset:512
    ds_read_b64_tr_b16 v[72:73], v100 offset:2048
    ds_read_b64_tr_b16 v[74:75], v100 offset:2560
    ds_read_b64_tr_b16 v[76:77], v101 offset:2048
    ds_read_b64_tr_b16 v[78:79], v101 offset:2560
    s_waitcnt vmcnt(8)
    ds_read_b64_tr_b16 v[80:81], v100 offset:4096
    ds_read_b64_tr_b16 v[82:83], v100 offset:4608
    ds_read_b64_tr_b16 v[84:85], v101 offset:4096
    ds_read_b64_tr_b16 v[86:87], v101 offset:4608
    ds_read_b64_tr_b16 v[88:89], v100 offset:6144
    ds_read_b64_tr_b16 v[90:91], v100 offset:6656
    ds_read_b64_tr_b16 v[92:93], v101 offset:6144
    ds_read_b64_tr_b16 v[94:95], v101 offset:6656
    s_waitcnt lgkmcnt(8)
    v_mfma_f32_32x32x16_bf16 v[0:15], v[64:67], v[72:75], 0
    v_mfma_f32_32x32x16_bf16 v[32:47], v[64:67], v[76:79], 0
    v_mfma_f32_32x32x16_bf16 v[16:31], v[68:71], v[72:75], 0
    v_mfma_f32_32x32x16_bf16 v[48:63], v[68:71], v[76:79], 0
    s_add_u32 m0, s40, 16384
    s_nop 0
    buffer_load_dwordx4 v96, s[8:11], s41 offen lds
    s_add_u32 m0, s40, 17408
    s_nop 0
    buffer_load_dwordx4 v97, s[8:11], s41 offen lds
    s_add_u32 m0, s40, 18432
    s_nop 0
    buffer_load_dwordx4 v98, s[12:15], s42 offen lds
    s_add_u32 m0, s40, 19456
    s_nop 0
    buffer_load_dwordx4 v99, s[12:15], s42 offen lds
    s_add_u32 s41, s41, 0x10000
    s_add_u32 s42, s42, 262144
    s_waitcnt vmcnt(8)
    ds_read_b64_tr_b16 v[64:65], v100 offset:8192
    ds_read_b64_tr_b16 v[66:67], v100 offset:8704
    ds_read_b64_tr_b16 v[68:69], v101 offset:8192
    ds_read_b64_tr_b16 v[70:71], v101 offset:8704
    ds_read_b64_tr_b16 v[72:73], v100 offset:10240
    ds_read_b64_tr_b16 v[74:75], v100 offset:10752
    ds_read_b64_tr_b16 v[76:77], v101 offset:10240
    ds_read_b64_tr_b16 v[78:79], v101 offset:10752
    s_waitcnt lgkmcnt(8)
    v_mfma_f32_32x32x16_bf16 v[0:15], v[80:83], v[88:91], v[0:15]
    v_mfma_f32_32x32x16_bf16 v[32:47], v[80:83], v[92:95], v[32:47]
    v_mfma_f32_32x32x16_bf16 v[16:31], v[84:87], v[88:91], v[16:31]
    v_mfma_f32_32x32x16_bf16 v[48:63], v[84:87], v[92:95], v[48:63]
    s_add_u32 m0, s40, 0
    s_nop 0
    buffer_load_dwordx4 v96, s[8:11], s41 offen lds
    s_add_u32 m0, s40, 1024
    s_nop 0
    buffer_load_dwordx4 v97, s[8:11], s41 offen lds
    s_add_u32 m0, s40, 2048
    s_nop 0
    buffer_load_dwordx4 v98, s[12:15], s42 offen lds
    s_add_u32 m0, s40, 3072
    s_nop 0
    buffer_load_dwordx4 v99, s[12:15], s42 offen lds
    s_add_u32 s41, s41, 0x10000
    s_add_u32 s42, s42, 262144
    s_waitcnt vmcnt(8)
    ds_read_b64_tr_b16 v[80:81], v100 offset:12288
    ds_read_b64_tr_b16 v[82:83], v100 offset:12800
    ds_read_b64_tr_b16 v[84:85], v101 offset:12288
    ds_read_b64_tr_b16 v[86:87], v101 offset:12800
    ds_read_b64_tr_b16 v[88:89], v100 offset:14336
    ds_read_b64_tr_b16 v[90:91], v100 offset:14848
    ds_read_b64_tr_b16 v[92:93], v101 offset:14336
    ds_read_b64_tr_b16 v[94:95], v101 offset:14848
    s_waitcnt lgkmcnt(8)
    v_mfma_f32_32x32x16_bf16 v[0:15], v[64:67], v[72:75], v[0:15]
    v_mfma_f32_32x32x16_bf16 v[32:47], v[64:67], v[76:79], v[32:47]
    v_mfma_f32_32x32x16_bf16 v[16:31], v[68:71], v[72:75], v[16:31]
    v_mfma_f32_32x32x16_bf16 v[48:63], v[68:71], v[76:79], v[48:63]
    s_add_u32 m0, s40, 4096
    s_nop 0
    buffer_load_dwordx4 v96, s[8:11], s41 offen lds
    s_add_u32 m0, s40, 5120
    s_nop 0
    buffer_load_dwordx4 v97, s[8:11], s41 offen lds
    s_add_u32 m0, s40, 6144
    s_nop 0
    buffer_load_dwordx4 v98, s[12:15], s42 offen lds
    s_add_u32 m0, s40, 7168
    s_nop 0
    buffer_load_dwordx4 v99, s[12:15], s42 offen lds
    s_add_u32 s41, s41, 0x10000
    s_add_u32 s42, s42, 262144
    s_waitcnt vmcnt(8)
    ds_read_b64_tr_b16 v[64:65], v100 offset:16384
    ds_read_b64_tr_b16 v[66:67], v100 offset:16896
    ds_read_b64_tr_b16 v[68:69], v101 offset:16384
    ds_read_b64_tr_b16 v[70:71], v101 offset:16896
    ds_read_b64_tr_b16 v[72:73], v100 offset:18432
    ds_read_b64_tr_b16 v[74:75], v100 offset:18944
    ds_read_b64_tr_b16 v[76:77], v101 offset:18432
    ds_read_b64_tr_b16 v[78:79], v101 offset:18944
    s_waitcnt lgkmcnt(8)
    v_mfma_f32_32x32x16_bf16 v[0:15], v[80:83], v[88:91], v[0:15]
    v_mfma_f32_32x32x16_bf16 v[32:47], v[80:83], v[92:95], v[32:47]
    v_mfma_f32_32x32x16_bf16 v[16:31], v[84:87], v[88:91], v[16:31]
    v_mfma_f32_32x32x16_bf16 v[48:63], v[84:87], v[92:95], v[48:63]
    s_add_u32 m0, s40, 8192
    s_nop 0
    buffer_load_dwordx4 v96, s[8:11], s41 offen lds
    s_add_u32 m0, s40, 9216
    s_nop 0
    buffer_load_dwordx4 v97, s[8:11], s41 offen lds
    s_add_u32 m0, s40, 10240
    s_nop 0
    buffer_load_dwordx4 v98, s[12:15], s42 offen lds
    s_add_u32 m0, s40, 11264
    s_nop 0
    buffer_load_dwordx4 v99, s[12:15], s42 offen lds
    s_add_u32 s41, s41, 0x10000
    s_add_u32 s42, s42, 262144
    s_waitcnt vmcnt(8)
    ds_read_b64_tr_b16 v[80:81], v100 offset:0
    ds_read_b64_tr_b16 v[82:83], v100 offset:512
    ds_read_b64_tr_b16 v[84:85], v101 offset:0
    ds_read_b64_tr_b16 v[86:87], v101 offset:512
    ds_read_b64_tr_b16 v[88:89], v100 offset:2048
    ds_read_b64_tr_b16 v[90:91], v100 offset:2560
    ds_read_b64_tr_b16 v[92:93], v101 offset:2048
    ds_read_b64_tr_b16 v[94:95], v101 offset:2560
    s_waitcnt lgkmcnt(8)
    v_mfma_f32_32x32x16_bf16 v[0:15], v[64:67], v[72:75], v[0:15]
    v_mfma_f32_32x32x16_bf16 v[32:47], v[64:67], v[76:79], v[32:47]
    v_mfma_f32_32x32x16_bf16 v[16:31], v[68:71], v[72:75], v[16:31]
    v_mfma_f32_32x32x16_bf16 v[48:63], v[68:71], v[76:79], v[48:63]
    s_add_u32 m0, s40, 12288
    s_nop 0
    buffer_load_dwordx4 v96, s[8:11], s41 offen lds
    s_add_u32 m0, s40, 13312
    s_nop 0
    buffer_load_dwordx4 v97, s[8:11], s41 offen lds
    s_add_u32 m0, s40, 14336
    s_nop 0
    buffer_load_dwordx4 v98, s[12:15], s42 offen lds
    s_add_u32 m0, s40, 15360
    s_nop 0
    buffer_load_dwordx4 v99, s[12:15], s42 offen lds
    s_add_u32 s41, s41, 0x10000
    s_add_u32 s42, s42, 262144
    s_waitcnt vmcnt(8)
    ds_read_b64_tr_b16 v[64:65], v100 offset:4096
    ds_read_b64_tr_b16 v[66:67], v100 offset:4608
    ds_read_b64_tr_b16 v[68:69], v101 offset:4096
    ds_read_b64_tr_b16 v[70:71], v101 offset:4608
    ds_read_b64_tr_b16 v[72:73], v100 offset:6144
    ds_read_b64_tr_b16 v[74:75], v100 offset:6656
    ds_read_b64_tr_b16 v[76:77], v101 offset:6144
    ds_read_b64_tr_b16 v[78:79], v101 offset:6656
    s_waitcnt lgkmcnt(8)
    v_mfma_f32_32x32x16_bf16 v[0:15], v[80:83], v[88:91], v[0:15]
    v_mfma_f32_32x32x16_bf16 v[32:47], v[80:83], v[92:95], v[32:47]
    v_mfma_f32_32x32x16_bf16 v[16:31], v[84:87], v[88:91], v[16:31]
    v_mfma_f32_32x32x16_bf16 v[48:63], v[84:87], v[92:95], v[48:63]
    s_add_u32 m0, s40, 16384
    s_nop 0
    buffer_load_dwordx4 v96, s[8:11], s41 offen lds
    s_add_u32 m0, s40, 17408
    s_nop 0
    buffer_load_dwordx4 v97, s[8:11], s41 offen lds
    s_add_u32 m0, s40, 18432
    s_nop 0
    buffer_load_dwordx4 v98, s[12:15], s42 offen lds
    s_add_u32 m0, s40, 19456
    s_nop 0
    buffer_load_dwordx4 v99, s[12:15], s42 offen lds
    s_add_u32 s41, s41, 0x10000
    s_add_u32 s42, s42, 262144
    s_waitcnt vmcnt(8)
    ds_read_b64_tr_b16 v[80:81], v100 offset:8192
    ds_read_b64_tr_b16 v[82:83], v100 offset:8704
    ds_read_b64_tr_b16 v[84:85], v101 offset:8192
    ds_read_b64_tr_b16 v[86:87], v101 offset:8704
    ds_read_b64_tr_b16 v[88:89], v100 offset:10240
    ds_read_b64_tr_b16 v[90:91], v100 offset:10752
    ds_read_b64_tr_b16 v[92:93], v101 offset:10240
    ds_read_b64_tr_b16 v[94:95], v101 offset:10752
    s_waitcnt lgkmcnt(8)
    v_mfma_f32_32x32x16_bf16 v[0:15], v[64:67], v[72:75], v[0:15]
    v_mfma_f32_32x32x16_bf16 v[32:47], v[64:67], v[76:79], v[32:47]
    v_mfma_f32_32x32x16_bf16 v[16:31], v[68:71], v[72:75], v[16:31]
    v_mfma_f32_32x32x16_bf16 v[48:63], v[68:71], v[76:79], v[48:63]
    s_add_u32 m0, s40, 0
    s_nop 0
    buffer_load_dwordx4 v96, s[8:11], s41 offen lds
    s_add_u32 m0, s40, 1024
    s_nop 0
    buffer_load_dwordx4 v97, s[8:11], s41 offen lds
    s_add_u32 m0, s40, 2048
    s_nop 0
    buffer_load_dwordx4 v98, s[12:15], s42 offen lds
    s_add_u32 m0, s40, 3072
    s_nop 0
    buffer_load_dwordx4 v99, s[12:15], s42 offen lds
    s_add_u32 s41, s41, 0x10000
    s_add_u32 s42, s42, 262144
    s_waitcnt vmcnt(8)
    ds_read_b64_tr_b16 v[64:65], v100 offset:12288
    ds_read_b64_tr_b16 v[66:67], v100 offset:12800
    ds_read_b64_tr_b16 v[68:69], v101 offset:12288
    ds_read_b64_tr_b16 v[70:71], v101 offset:12800
    ds_read_b64_tr_b16 v[72:73], v100 offset:14336
    ds_read_b64_tr_b16 v[74:75], v100 offset:14848
    ds_read_b64_tr_b16 v[76:77], v101 offset:14336
    ds_read_b64_tr_b16 v[78:79], v101 offset:14848
    s_waitcnt lgkmcnt(8)
    v_mfma_f32_32x32x16_bf16 v[0:15], v[80:83], v[88:91], v[0:15]
    v_mfma_f32_32x32x16_bf16 v[32:47], v[80:83], v[92:95], v[32:47]
    v_mfma_f32_32x32x16_bf16 v[16:31], v[84:87], v[88:91], v[16:31]
    v_mfma_f32_32x32x16_bf16 v[48:63], v[84:87], v[92:95], v[48:63]
    s_add_u32 m0, s40, 4096
    s_nop 0
    buffer_load_dwordx4 v96, s[8:11], s41 offen lds
    s_add_u32 m0, s40, 5120
    s_nop 0
    buffer_load_dwordx4 v97, s[8:11], s41 offen lds
    s_add_u32 m0, s40, 6144
    s_nop 0
    buffer_load_dwordx4 v98, s[12:15], s42 offen lds
    s_add_u32 m0, s40, 7168
    s_nop 0
    buffer_load_dwordx4 v99, s[12:15], s42 offen lds
    s_add_u32 s41, s41, 0x10000
    s_add_u32 s42, s42, 262144
    s_waitcnt vmcnt(8)
    ds_read_b64_tr_b16 v[80:81], v100 offset:16384
    ds_read_b64_tr_b16 v[82:83], v100 offset:16896
    ds_read_b64_tr_b16 v[84:85], v101 offset:16384
    ds_read_b64_tr_b16 v[86:87], v101 offset:16896
    ds_read_b64_tr_b16 v[88:89], v100 offset:18432
    ds_read_b64_tr_b16 v[90:91], v100 offset:18944
    ds_read_b64_tr_b16 v[92:93], v101 offset:18432
    ds_read_b64_tr_b16 v[94:95], v101 offset:18944
    s_waitcnt lgkmcnt(8)
    v_mfma_f32_32x32x16_bf16 v[0:15], v[64:67], v[72:75], v[0:15]
    v_mfma_f32_32x32x16_bf16 v[32:47], v[64:67], v[76:79], v[32:47]
    v_mfma_f32_32x32x16_bf16 v[16:31], v[68:71], v[72:75], v[16:31]
    v_mfma_f32_32x32x16_bf16 v[48:63], v[68:71], v[76:79], v[48:63]
    s_add_u32 m0, s40, 8192
    s_nop 0
    buffer_load_dwordx4 v96, s[8:11], s41 offen lds
    s_add_u32 m0, s40, 9216
    s_nop 0
    buffer_load_dwordx4 v97, s[8:11], s41 offen lds
    s_add_u32 m0, s40, 10240
    s_nop 0
    buffer_load_dwordx4 v98, s[12:15], s42 offen lds
    s_add_u32 m0, s40, 11264
    s_nop 0
    buffer_load_dwordx4 v99, s[12:15], s42 offen lds
    s_add_u32 s41, s41, 0x10000
    s_add_u32 s42, s42, 262144
    s_waitcnt vmcnt(8)
    ds_read_b64_tr_b16 v[64:65], v100 offset:0
    ds_read_b64_tr_b16 v[66:67], v100 offset:512
    ds_read_b64_tr_b16 v[68:69], v101 offset:0
    ds_read_b64_tr_b16 v[70:71], v101 offset:512
    ds_read_b64_tr_b16 v[72:73], v100 offset:2048
    ds_read_b64_tr_b16 v[74:75], v100 offset:2560
    ds_read_b64_tr_b16 v[76:77], v101 offset:2048
    ds_read_b64_tr_b16 v[78:79], v101 offset:2560
    s_waitcnt lgkmcnt(8)
    v_mfma_f32_32x32x16_bf16 v[0:15], v[80:83], v[88:91], v[0:15]
    v_mfma_f32_32x32x16_bf16 v[32:47], v[80:83], v[92:95], v[32:47]
    v_mfma_f32_32x32x16_bf16 v[16:31], v[84:87], v[88:91], v[16:31]
    v_mfma_f32_32x32x16_bf16 v[48:63], v[84:87], v[92:95], v[48:63]
    s_add_u32 m0, s40, 12288
    s_nop 0
    buffer_load_dwordx4 v96, s[8:11], s41 offen lds
    s_add_u32 m0, s40, 13312
    s_nop 0
    buffer_load_dwordx4 v97, s[8:11], s41 offen lds
    s_add_u32 m0, s40, 14336
    s_nop 0
    buffer_load_dwordx4 v98, s[12:15], s42 offen lds
    s_add_u32 m0, s40, 15360
    s_nop 0
    buffer_load_dwordx4 v99, s[12:15], s42 offen lds
    s_add_u32 s41, s41, 0x10000
    s_add_u32 s42, s42, 262144
    s_waitcnt vmcnt(8)
    ds_read_b64_tr_b16 v[80:81], v100 offset:4096
    ds_read_b64_tr_b16 v[82:83], v100 offset:4608
    ds_read_b64_tr_b16 v[84:85], v101 offset:4096
    ds_read_b64_tr_b16 v[86:87], v101 offset:4608
    ds_read_b64_tr_b16 v[88:89], v100 offset:6144
    ds_read_b64_tr_b16 v[90:91], v100 offset:6656
    ds_read_b64_tr_b16 v[92:93], v101 offset:6144
    ds_read_b64_tr_b16 v[94:95], v101 offset:6656
    s_waitcnt lgkmcnt(8)
    v_mfma_f32_32x32x16_bf16 v[0:15], v[64:67], v[72:75], v[0:15]
    v_mfma_f32_32x32x16_bf16 v[32:47], v[64:67], v[76:79], v[32:47]
    v_mfma_f32_32x32x16_bf16 v[16:31], v[68:71], v[72:75], v[16:31]
    v_mfma_f32_32x32x16_bf16 v[48:63], v[68:71], v[76:79], v[48:63]
    s_add_u32 m0, s40, 16384
    s_nop 0
    buffer_load_dwordx4 v96, s[8:11], s41 offen lds
    s_add_u32 m0, s40, 17408
    s_nop 0
    buffer_load_dwordx4 v97, s[8:11], s41 offen lds
    s_add_u32 m0, s40, 18432
    s_nop 0
    buffer_load_dwordx4 v98, s[12:15], s42 offen lds
    s_add_u32 m0, s40, 19456
    s_nop 0
    buffer_load_dwordx4 v99, s[12:15], s42 offen lds
    s_add_u32 s41, s41, 0x10000
    s_add_u32 s42, s42, 262144
    s_waitcnt vmcnt(8)
    ds_read_b64_tr_b16 v[64:65], v100 offset:8192
    ds_read_b64_tr_b16 v[66:67], v100 offset:8704
    ds_read_b64_tr_b16 v[68:69], v101 offset:8192
    ds_read_b64_tr_b16 v[70:71], v101 offset:8704
    ds_read_b64_tr_b16 v[72:73], v100 offset:10240
    ds_read_b64_tr_b16 v[74:75], v100 offset:10752
    ds_read_b64_tr_b16 v[76:77], v101 offset:10240
    ds_read_b64_tr_b16 v[78:79], v101 offset:10752
    s_waitcnt lgkmcnt(8)
    v_mfma_f32_32x32x16_bf16 v[0:15], v[80:83], v[88:91], v[0:15]
    v_mfma_f32_32x32x16_bf16 v[32:47], v[80:83], v[92:95], v[32:47]
    v_mfma_f32_32x32x16_bf16 v[16:31], v[84:87], v[88:91], v[16:31]
    v_mfma_f32_32x32x16_bf16 v[48:63], v[84:87], v[92:95], v[48:63]
    s_add_u32 m0, s40, 0
    s_nop 0
    buffer_load_dwordx4 v96, s[8:11], s41 offen lds
    s_add_u32 m0, s40, 1024
    s_nop 0
    buffer_load_dwordx4 v97, s[8:11], s41 offen lds
    s_add_u32 m0, s40, 2048
    s_nop 0
    buffer_load_dwordx4 v98, s[12:15], s42 offen lds
    s_add_u32 m0, s40, 3072
    s_nop 0
    buffer_load_dwordx4 v99, s[12:15], s42 offen lds
    s_add_u32 s41, s41, 0x10000
    s_add_u32 s42, s42, 262144
    s_waitcnt vmcnt(8)
    ds_read_b64_tr_b16 v[80:81], v100 offset:12288
    ds_read_b64_tr_b16 v[82:83], v100 offset:12800
    ds_read_b64_tr_b16 v[84:85], v101 offset:12288
    ds_read_b64_tr_b16 v[86:87], v101 offset:12800
    ds_read_b64_tr_b16 v[88:89], v100 offset:14336
    ds_read_b64_tr_b16 v[90:91], v100 offset:14848
    ds_read_b64_tr_b16 v[92:93], v101 offset:14336
    ds_read_b64_tr_b16 v[94:95], v101 offset:14848
    s_waitcnt lgkmcnt(8)
    v_mfma_f32_32x32x16_bf16 v[0:15], v[64:67], v[72:75], v[0:15]
    v_mfma_f32_32x32x16_bf16 v[32:47], v[64:67], v[76:79], v[32:47]
    v_mfma_f32_32x32x16_bf16 v[16:31], v[68:71], v[72:75], v[16:31]
    v_mfma_f32_32x32x16_bf16 v[48:63], v[68:71], v[76:79], v[48:63]
    s_add_u32 m0, s40, 4096
    s_nop 0
    buffer_load_dwordx4 v96, s[8:11], s41 offen lds
    s_add_u32 m0, s40, 5120
    s_nop 0
    buffer_load_dwordx4 v97, s[8:11], s41 offen lds
    s_add_u32 m0, s40, 6144
    s_nop 0
    buffer_load_dwordx4 v98, s[12:15], s42 offen lds
    s_add_u32 m0, s40, 7168
    s_nop 0
    buffer_load_dwordx4 v99, s[12:15], s42 offen lds
    s_add_u32 s41, s41, 0x10000
    s_add_u32 s42, s42, 262144
    s_waitcnt vmcnt(8)
    ds_read_b64_tr_b16 v[64:65], v100 offset:16384
    ds_read_b64_tr_b16 v[66:67], v100 offset:16896
    ds_read_b64_tr_b16 v[68:69], v101 offset:16384
    ds_read_b64_tr_b16 v[70:71], v101 offset:16896
    ds_read_b64_tr_b16 v[72:73], v100 offset:18432
    ds_read_b64_tr_b16 v[74:75], v100 offset:18944
    ds_read_b64_tr_b16 v[76:77], v101 offset:18432
    ds_read_b64_tr_b16 v[78:79], v101 offset:18944
    s_waitcnt lgkmcnt(8)
    v_mfma_f32_32x32x16_bf16 v[0:15], v[80:83], v[88:91], v[0:15]
    v_mfma_f32_32x32x16_bf16 v[32:47], v[80:83], v[92:95], v[32:47]
    v_mfma_f32_32x32x16_bf16 v[16:31], v[84:87], v[88:91], v[16:31]
    v_mfma_f32_32x32x16_bf16 v[48:63], v[84:87], v[92:95], v[48:63]
    s_add_u32 m0, s40, 8192
    s_nop 0
    buffer_load_dwordx4 v96, s[8:11], s41 offen lds
    s_add_u32 m0, s40, 9216
    s_nop 0
    buffer_load_dwordx4 v97, s[8:11], s41 offen lds
    s_add_u32 m0, s40, 10240
    s_nop 0
    buffer_load_dwordx4 v98, s[12:15], s42 offen lds
    s_add_u32 m0, s40, 11264
    s_nop 0
    buffer_load_dwordx4 v99, s[12:15], s42 offen lds
    s_add_u32 s41, s41, 0x10000
    s_add_u32 s42, s42, 262144
    s_waitcnt vmcnt(8)
    ds_read_b64_tr_b16 v[80:81], v100 offset:0
    ds_read_b64_tr_b16 v[82:83], v100 offset:512
    ds_read_b64_tr_b16 v[84:85], v101 offset:0
    ds_read_b64_tr_b16 v[86:87], v101 offset:512
    ds_read_b64_tr_b16 v[88:89], v100 offset:2048
    ds_read_b64_tr_b16 v[90:91], v100 offset:2560
    ds_read_b64_tr_b16 v[92:93], v101 offset:2048
    ds_read_b64_tr_b16 v[94:95], v101 offset:2560
    s_waitcnt lgkmcnt(8)
    v_mfma_f32_32x32x16_bf16 v[0:15], v[64:67], v[72:75], v[0:15]
    v_mfma_f32_32x32x16_bf16 v[32:47], v[64:67], v[76:79], v[32:47]
    v_mfma_f32_32x32x16_bf16 v[16:31], v[68:71], v[72:75], v[16:31]
    v_mfma_f32_32x32x16_bf16 v[48:63], v[68:71], v[76:79], v[48:63]
    s_add_u32 m0, s40, 12288
    s_nop 0
    buffer_load_dwordx4 v96, s[8:11], s41 offen lds
    s_add_u32 m0, s40, 13312
    s_nop 0
    buffer_load_dwordx4 v97, s[8:11], s41 offen lds
    s_add_u32 m0, s40, 14336
    s_nop 0
    buffer_load_dwordx4 v98, s[12:15], s42 offen lds
    s_add_u32 m0, s40, 15360
    s_nop 0
    buffer_load_dwordx4 v99, s[12:15], s42 offen lds
    s_add_u32 s41, s41, 0x10000
    s_add_u32 s42, s42, 262144
    s_waitcnt vmcnt(8)
    ds_read_b64_tr_b16 v[64:65], v100 offset:4096
    ds_read_b64_tr_b16 v[66:67], v100 offset:4608
    ds_read_b64_tr_b16 v[68:69], v101 offset:4096
    ds_read_b64_tr_b16 v[70:71], v101 offset:4608
    ds_read_b64_tr_b16 v[72:73], v100 offset:6144
    ds_read_b64_tr_b16 v[74:75], v100 offset:6656
    ds_read_b64_tr_b16 v[76:77], v101 offset:6144
    ds_read_b64_tr_b16 v[78:79], v101 offset:6656
    s_waitcnt lgkmcnt(8)
    v_mfma_f32_32x32x16_bf16 v[0:15], v[80:83], v[88:91], v[0:15]
    v_mfma_f32_32x32x16_bf16 v[32:47], v[80:83], v[92:95], v[32:47]
    v_mfma_f32_32x32x16_bf16 v[16:31], v[84:87], v[88:91], v[16:31]
    v_mfma_f32_32x32x16_bf16 v[48:63], v[84:87], v[92:95], v[48:63]
    s_add_u32 m0, s40, 16384
    s_nop 0
    buffer_load_dwordx4 v96, s[8:11], s41 offen lds
    s_add_u32 m0, s40, 17408
    s_nop 0
    buffer_load_dwordx4 v97, s[8:11], s41 offen lds
    s_add_u32 m0, s40, 18432
    s_nop 0
    buffer_load_dwordx4 v98, s[12:15], s42 offen lds
    s_add_u32 m0, s40, 19456
    s_nop 0
    buffer_load_dwordx4 v99, s[12:15], s42 offen lds
    s_add_u32 s41, s41, 0x10000
    s_add_u32 s42, s42, 262144
    s_waitcnt vmcnt(8)
    ds_read_b64_tr_b16 v[80:81], v100 offset:8192
    ds_read_b64_tr_b16 v[82:83], v100 offset:8704
    ds_read_b64_tr_b16 v[84:85], v101 offset:8192
    ds_read_b64_tr_b16 v[86:87], v101 offset:8704
    ds_read_b64_tr_b16 v[88:89], v100 offset:10240
    ds_read_b64_tr_b16 v[90:91], v100 offset:10752
    ds_read_b64_tr_b16 v[92:93], v101 offset:10240
    ds_read_b64_tr_b16 v[94:95], v101 offset:10752
    s_waitcnt lgkmcnt(8)
    v_mfma_f32_32x32x16_bf16 v[0:15], v[64:67], v[72:75], v[0:15]
    v_mfma_f32_32x32x16_bf16 v[32:47], v[64:67], v[76:79], v[32:47]
    v_mfma_f32_32x32x16_bf16 v[16:31], v[68:71], v[72:75], v[16:31]
    v_mfma_f32_32x32x16_bf16 v[48:63], v[68:71], v[76:79], v[48:63]
    s_add_u32 m0, s40, 0
    s_nop 0
    buffer_load_dwordx4 v96, s[8:11], s41 offen lds
    s_add_u32 m0, s40, 1024
    s_nop 0
    buffer_load_dwordx4 v97, s[8:11], s41 offen lds
    s_add_u32 m0, s40, 2048
    s_nop 0
    buffer_load_dwordx4 v98, s[12:15], s42 offen lds
    s_add_u32 m0, s40, 3072
    s_nop 0
    buffer_load_dwordx4 v99, s[12:15], s42 offen lds
    s_add_u32 s41, s41, 0x10000
    s_add_u32 s42, s42, 262144
    s_waitcnt vmcnt(8)
    ds_read_b64_tr_b16 v[64:65], v100 offset:12288
    ds_read_b64_tr_b16 v[66:67], v100 offset:12800
    ds_read_b64_tr_b16 v[68:69], v101 offset:12288
    ds_read_b64_tr_b16 v[70:71], v101 offset:12800
    ds_read_b64_tr_b16 v[72:73], v100 offset:14336
    ds_read_b64_tr_b16 v[74:75], v100 offset:14848
    ds_read_b64_tr_b16 v[76:77], v101 offset:14336
    ds_read_b64_tr_b16 v[78:79], v101 offset:14848
    s_waitcnt lgkmcnt(8)
    v_mfma_f32_32x32x16_bf16 v[0:15], v[80:83], v[88:91], v[0:15]
    v_mfma_f32_32x32x16_bf16 v[32:47], v[80:83], v[92:95], v[32:47]
    v_mfma_f32_32x32x16_bf16 v[16:31], v[84:87], v[88:91], v[16:31]
    v_mfma_f32_32x32x16_bf16 v[48:63], v[84:87], v[92:95], v[48:63]
    s_add_u32 m0, s40, 4096
    s_nop 0
    buffer_load_dwordx4 v96, s[8:11], s41 offen lds
    s_add_u32 m0, s40, 5120
    s_nop 0
    buffer_load_dwordx4 v97, s[8:11], s41 offen lds
    s_add_u32 m0, s40, 6144
    s_nop 0
    buffer_load_dwordx4 v98, s[12:15], s42 offen lds
    s_add_u32 m0, s40, 7168
    s_nop 0
    buffer_load_dwordx4 v99, s[12:15], s42 offen lds
    s_add_u32 s41, s41, 0x10000
    s_add_u32 s42, s42, 262144
    s_waitcnt vmcnt(8)
    ds_read_b64_tr_b16 v[80:81], v100 offset:16384
    ds_read_b64_tr_b16 v[82:83], v100 offset:16896
    ds_read_b64_tr_b16 v[84:85], v101 offset:16384
    ds_read_b64_tr_b16 v[86:87], v101 offset:16896
    ds_read_b64_tr_b16 v[88:89], v100 offset:18432
    ds_read_b64_tr_b16 v[90:91], v100 offset:18944
    ds_read_b64_tr_b16 v[92:93], v101 offset:18432
    ds_read_b64_tr_b16 v[94:95], v101 offset:18944
    s_waitcnt lgkmcnt(8)
    v_mfma_f32_32x32x16_bf16 v[0:15], v[64:67], v[72:75], v[0:15]
    v_mfma_f32_32x32x16_bf16 v[32:47], v[64:67], v[76:79], v[32:47]
    v_mfma_f32_32x32x16_bf16 v[16:31], v[68:71], v[72:75], v[16:31]
    v_mfma_f32_32x32x16_bf16 v[48:63], v[68:71], v[76:79], v[48:63]
    s_add_u32 m0, s40, 8192
    s_nop 0
    buffer_load_dwordx4 v96, s[8:11], s41 offen lds
    s_add_u32 m0, s40, 9216
    s_nop 0
    buffer_load_dwordx4 v97, s[8:11], s41 offen lds
    s_add_u32 m0, s40, 10240
    s_nop 0
    buffer_load_dwordx4 v98, s[12:15], s42 offen lds
    s_add_u32 m0, s40, 11264
    s_nop 0
    buffer_load_dwordx4 v99, s[12:15], s42 offen lds
    s_add_u32 s41, s41, 0x10000
    s_add_u32 s42, s42, 262144
    s_waitcnt vmcnt(8)
    ds_read_b64_tr_b16 v[64:65], v100 offset:0
    ds_read_b64_tr_b16 v[66:67], v100 offset:512
    ds_read_b64_tr_b16 v[68:69], v101 offset:0
    ds_read_b64_tr_b16 v[70:71], v101 offset:512
    ds_read_b64_tr_b16 v[72:73], v100 offset:2048
    ds_read_b64_tr_b16 v[74:75], v100 offset:2560
    ds_read_b64_tr_b16 v[76:77], v101 offset:2048
    ds_read_b64_tr_b16 v[78:79], v101 offset:2560
    s_waitcnt lgkmcnt(8)
    v_mfma_f32_32x32x16_bf16 v[0:15], v[80:83], v[88:91], v[0:15]
    v_mfma_f32_32x32x16_bf16 v[32:47], v[80:83], v[92:95], v[32:47]
    v_mfma_f32_32x32x16_bf16 v[16:31], v[84:87], v[88:91], v[16:31]
    v_mfma_f32_32x32x16_bf16 v[48:63], v[84:87], v[92:95], v[48:63]
    s_add_u32 m0, s40, 12288
    s_nop 0
    buffer_load_dwordx4 v96, s[8:11], s41 offen lds
    s_add_u32 m0, s40, 13312
    s_nop 0
    buffer_load_dwordx4 v97, s[8:11], s41 offen lds
    s_add_u32 m0, s40, 14336
    s_nop 0
    buffer_load_dwordx4 v98, s[12:15], s42 offen lds
    s_add_u32 m0, s40, 15360
    s_nop 0
    buffer_load_dwordx4 v99, s[12:15], s42 offen lds
    s_add_u32 s41, s41, 0x10000
    s_add_u32 s42, s42, 262144
    s_waitcnt vmcnt(8)
    ds_read_b64_tr_b16 v[80:81], v100 offset:4096
    ds_read_b64_tr_b16 v[82:83], v100 offset:4608
    ds_read_b64_tr_b16 v[84:85], v101 offset:4096
    ds_read_b64_tr_b16 v[86:87], v101 offset:4608
    ds_read_b64_tr_b16 v[88:89], v100 offset:6144
    ds_read_b64_tr_b16 v[90:91], v100 offset:6656
    ds_read_b64_tr_b16 v[92:93], v101 offset:6144
    ds_read_b64_tr_b16 v[94:95], v101 offset:6656
    s_waitcnt lgkmcnt(8)
    v_mfma_f32_32x32x16_bf16 v[0:15], v[64:67], v[72:75], v[0:15]
    v_mfma_f32_32x32x16_bf16 v[32:47], v[64:67], v[76:79], v[32:47]
    v_mfma_f32_32x32x16_bf16 v[16:31], v[68:71], v[72:75], v[16:31]
    v_mfma_f32_32x32x16_bf16 v[48:63], v[68:71], v[76:79], v[48:63]
    s_add_u32 m0, s40, 16384
    s_nop 0
    buffer_load_dwordx4 v96, s[8:11], s41 offen lds
    s_add_u32 m0, s40, 17408
    s_nop 0
    buffer_load_dwordx4 v97, s[8:11], s41 offen lds
    s_add_u32 m0, s40, 18432
    s_nop 0
    buffer_load_dwordx4 v98, s[12:15], s42 offen lds
    s_add_u32 m0, s40, 19456
    s_nop 0
    buffer_load_dwordx4 v99, s[12:15], s42 offen lds
    s_add_u32 s41, s41, 0x10000
    s_add_u32 s42, s42, 262144
    s_waitcnt vmcnt(8)
    ds_read_b64_tr_b16 v[64:65], v100 offset:8192
    ds_read_b64_tr_b16 v[66:67], v100 offset:8704
    ds_read_b64_tr_b16 v[68:69], v101 offset:8192
    ds_read_b64_tr_b16 v[70:71], v101 offset:8704
    ds_read_b64_tr_b16 v[72:73], v100 offset:10240
    ds_read_b64_tr_b16 v[74:75], v100 offset:10752
    ds_read_b64_tr_b16 v[76:77], v101 offset:10240
    ds_read_b64_tr_b16 v[78:79], v101 offset:10752
    s_waitcnt lgkmcnt(8)
    v_mfma_f32_32x32x16_bf16 v[0:15], v[80:83], v[88:91], v[0:15]
    v_mfma_f32_32x32x16_bf16 v[32:47], v[80:83], v[92:95], v[32:47]
    v_mfma_f32_32x32x16_bf16 v[16:31], v[84:87], v[88:91], v[16:31]
    v_mfma_f32_32x32x16_bf16 v[48:63], v[84:87], v[92:95], v[48:63]
    s_add_u32 m0, s40, 0
    s_nop 0
    buffer_load_dwordx4 v96, s[8:11], s41 offen lds
    s_add_u32 m0, s40, 1024
    s_nop 0
    buffer_load_dwordx4 v97, s[8:11], s41 offen lds
    s_add_u32 m0, s40, 2048
    s_nop 0
    buffer_load_dwordx4 v98, s[12:15], s42 offen lds
    s_add_u32 m0, s40, 3072
    s_nop 0
    buffer_load_dwordx4 v99, s[12:15], s42 offen lds
    s_add_u32 s41, s41, 0x10000
    s_add_u32 s42, s42, 262144
    s_waitcnt vmcnt(8)
    ds_read_b64_tr_b16 v[80:81], v100 offset:12288
    ds_read_b64_tr_b16 v[82:83], v100 offset:12800
    ds_read_b64_tr_b16 v[84:85], v101 offset:12288
    ds_read_b64_tr_b16 v[86:87], v101 offset:12800
    ds_read_b64_tr_b16 v[88:89], v100 offset:14336
    ds_read_b64_tr_b16 v[90:91], v100 offset:14848
    ds_read_b64_tr_b16 v[92:93], v101 offset:14336
    ds_read_b64_tr_b16 v[94:95], v101 offset:14848
    s_waitcnt lgkmcnt(8)
    v_mfma_f32_32x32x16_bf16 v[0:15], v[64:67], v[72:75], v[0:15]
    v_mfma_f32_32x32x16_bf16 v[32:47], v[64:67], v[76:79], v[32:47]
    v_mfma_f32_32x32x16_bf16 v[16:31], v[68:71], v[72:75], v[16:31]
    v_mfma_f32_32x32x16_bf16 v[48:63], v[68:71], v[76:79], v[48:63]
    s_add_u32 m0, s40, 4096
    s_nop 0
    buffer_load_dwordx4 v96, s[8:11], s41 offen lds
    s_add_u32 m0, s40, 5120
    s_nop 0
    buffer_load_dwordx4 v97, s[8:11], s41 offen lds
    s_add_u32 m0, s40, 6144
    s_nop 0
    buffer_load_dwordx4 v98, s[12:15], s42 offen lds
    s_add_u32 m0, s40, 7168
    s_nop 0
    buffer_load_dwordx4 v99, s[12:15], s42 offen lds
    s_add_u32 s41, s41, 0x10000
    s_add_u32 s42, s42, 262144
    s_waitcnt vmcnt(8)
    ds_read_b64_tr_b16 v[64:65], v100 offset:16384
    ds_read_b64_tr_b16 v[66:67], v100 offset:16896
    ds_read_b64_tr_b16 v[68:69], v101 offset:16384
    ds_read_b64_tr_b16 v[70:71], v101 offset:16896
    ds_read_b64_tr_b16 v[72:73], v100 offset:18432
    ds_read_b64_tr_b16 v[74:75], v100 offset:18944
    ds_read_b64_tr_b16 v[76:77], v101 offset:18432
    ds_read_b64_tr_b16 v[78:79], v101 offset:18944
    s_waitcnt lgkmcnt(8)
    v_mfma_f32_32x32x16_bf16 v[0:15], v[80:83], v[88:91], v[0:15]
    v_mfma_f32_32x32x16_bf16 v[32:47], v[80:83], v[92:95], v[32:47]
    v_mfma_f32_32x32x16_bf16 v[16:31], v[84:87], v[88:91], v[16:31]
    v_mfma_f32_32x32x16_bf16 v[48:63], v[84:87], v[92:95], v[48:63]
    s_add_u32 m0, s40, 8192
    s_nop 0
    buffer_load_dwordx4 v96, s[8:11], s41 offen lds
    s_add_u32 m0, s40, 9216
    s_nop 0
    buffer_load_dwordx4 v97, s[8:11], s41 offen lds
    s_add_u32 m0, s40, 10240
    s_nop 0
    buffer_load_dwordx4 v98, s[12:15], s42 offen lds
    s_add_u32 m0, s40, 11264
    s_nop 0
    buffer_load_dwordx4 v99, s[12:15], s42 offen lds
    s_add_u32 s41, s41, 0x10000
    s_add_u32 s42, s42, 262144
    s_waitcnt vmcnt(8)
    ds_read_b64_tr_b16 v[80:81], v100 offset:0
    ds_read_b64_tr_b16 v[82:83], v100 offset:512
    ds_read_b64_tr_b16 v[84:85], v101 offset:0
    ds_read_b64_tr_b16 v[86:87], v101 offset:512
    ds_read_b64_tr_b16 v[88:89], v100 offset:2048
    ds_read_b64_tr_b16 v[90:91], v100 offset:2560
    ds_read_b64_tr_b16 v[92:93], v101 offset:2048
    ds_read_b64_tr_b16 v[94:95], v101 offset:2560
    s_waitcnt lgkmcnt(8)
    v_mfma_f32_32x32x16_bf16 v[0:15], v[64:67], v[72:75], v[0:15]
    v_mfma_f32_32x32x16_bf16 v[32:47], v[64:67], v[76:79], v[32:47]
    v_mfma_f32_32x32x16_bf16 v[16:31], v[68:71], v[72:75], v[16:31]
    v_mfma_f32_32x32x16_bf16 v[48:63], v[68:71], v[76:79], v[48:63]
    s_waitcnt vmcnt(4)
    ds_read_b64_tr_b16 v[64:65], v100 offset:4096
    ds_read_b64_tr_b16 v[66:67], v100 offset:4608
    ds_read_b64_tr_b16 v[68:69], v101 offset:4096
    ds_read_b64_tr_b16 v[70:71], v101 offset:4608
    ds_read_b64_tr_b16 v[72:73], v100 offset:6144
    ds_read_b64_tr_b16 v[74:75], v100 offset:6656
    ds_read_b64_tr_b16 v[76:77], v101 offset:6144
    ds_read_b64_tr_b16 v[78:79], v101 offset:6656
    s_waitcnt lgkmcnt(8)
    v_mfma_f32_32x32x16_bf16 v[0:15], v[80:83], v[88:91], v[0:15]
    v_mfma_f32_32x32x16_bf16 v[32:47], v[80:83], v[92:95], v[32:47]
    v_mfma_f32_32x32x16_bf16 v[16:31], v[84:87], v[88:91], v[16:31]
    v_mfma_f32_32x32x16_bf16 v[48:63], v[84:87], v[92:95], v[48:63]
    s_waitcnt vmcnt(0)
    ds_read_b64_tr_b16 v[80:81], v100 offset:8192
    ds_read_b64_tr_b16 v[82:83], v100 offset:8704
    ds_read_b64_tr_b16 v[84:85], v101 offset:8192
    ds_read_b64_tr_b16 v[86:87], v101 offset:8704
    ds_read_b64_tr_b16 v[88:89], v100 offset:10240
    ds_read_b64_tr_b16 v[90:91], v100 offset:10752
    ds_read_b64_tr_b16 v[92:93], v101 offset:10240
    ds_read_b64_tr_b16 v[94:95], v101 offset:10752
    s_waitcnt lgkmcnt(8)
    v_mfma_f32_32x32x16_bf16 v[0:15], v[64:67], v[72:75], v[0:15]
    v_mfma_f32_32x32x16_bf16 v[32:47], v[64:67], v[76:79], v[32:47]
    v_mfma_f32_32x32x16_bf16 v[16:31], v[68:71], v[72:75], v[16:31]
    v_mfma_f32_32x32x16_bf16 v[48:63], v[68:71], v[76:79], v[48:63]
    s_waitcnt lgkmcnt(0)
    v_mfma_f32_32x32x16_bf16 v[0:15], v[80:83], v[88:91], v[0:15]
    v_mfma_f32_32x32x16_bf16 v[32:47], v[80:83], v[92:95], v[32:47]
    v_mfma_f32_32x32x16_bf16 v[16:31], v[84:87], v[88:91], v[16:31]
    v_mfma_f32_32x32x16_bf16 v[48:63], v[84:87], v[92:95], v[48:63]
    s_lshr_b32 s50, s43, 1
    s_lshl_b32 s50, s50, 6
    s_add_u32 s50, s50, s49
    v_and_b32 v104, 31, v102
    v_lshlrev_b32 v105, 1, v104
    buffer_load_ushort v106, v105, s[16:19], s50 offen
    s_and_b32 s51, s43, 1
    s_lshl_b32 s51, s51, 6
    s_add_u32 s51, s51, s48
    v_lshrrev_b32 v107, 5, v102
    v_lshlrev_b32 v107, 3, v107
    buffer_load_dwordx2 v[64:65], v107, s[32:35], s51 offen offset:0
    buffer_load_dwordx2 v[66:67], v107, s[32:35], s51 offen offset:16
    buffer_load_dwordx2 v[68:69], v107, s[32:35], s51 offen offset:32
    buffer_load_dwordx2 v[70:71], v107, s[32:35], s51 offen offset:48
    v_lshl_add_u32 v105, v104, 10, v107
    s_lshl_b32 s52, s50, 9
    s_add_u32 s52, s52, s51
    buffer_load_dwordx2 v[72:73], v105, s[28:31], s52 offen offset:0
    buffer_load_dwordx2 v[74:75], v105, s[28:31], s52 offen offset:16
    buffer_load_dwordx2 v[76:77], v105, s[28:31], s52 offen offset:32
    buffer_load_dwordx2 v[78:79], v105, s[28:31], s52 offen offset:48
    buffer_load_dwordx2 v[80:81], v105, s[24:27], s52 offen offset:0
    buffer_load_dwordx2 v[82:83], v105, s[24:27], s52 offen offset:16
    buffer_load_dwordx2 v[84:85], v105, s[24:27], s52 offen offset:32
    buffer_load_dwordx2 v[86:87], v105, s[24:27], s52 offen offset:48
    v_lshlrev_b32 v108, 11, v107
    v_lshl_add_u32 v108, v104, 1, v108
    s_lshl_b32 s53, s51, 11
    s_add_u32 s53, s53, s50
    s_add_u32 s53, s53, 0xa00000
    s_add_u32 s58, s53, 0
    v_mov_b32 v109, v108
    buffer_load_ushort v112, v109, s[24:27], s58 offen
    v_add_u32 v109, 4096, v108
    buffer_load_ushort v113, v109, s[24:27], s58 offen
    v_add_u32 v109, 8192, v108
    buffer_load_ushort v114, v109, s[24:27], s58 offen
    v_add_u32 v109, 12288, v108
    buffer_load_ushort v115, v109, s[24:27], s58 offen
    s_add_u32 s58, s53, 32768
    v_mov_b32 v109, v108
    buffer_load_ushort v116, v109, s[24:27], s58 offen
    v_add_u32 v109, 4096, v108
    buffer_load_ushort v117, v109, s[24:27], s58 offen
    v_add_u32 v109, 8192, v108
    buffer_load_ushort v118, v109, s[24:27], s58 offen
    v_add_u32 v109, 12288, v108
    buffer_load_ushort v119, v109, s[24:27], s58 offen
    s_add_u32 s58, s53, 65536
    v_mov_b32 v109, v108
    buffer_load_ushort v120, v109, s[24:27], s58 offen
    v_add_u32 v109, 4096, v108
    buffer_load_ushort v121, v109, s[24:27], s58 offen
    v_add_u32 v109, 8192, v108
    buffer_load_ushort v122, v109, s[24:27], s58 offen
    v_add_u32 v109, 12288, v108
    buffer_load_ushort v123, v109, s[24:27], s58 offen
    s_add_u32 s58, s53, 98304
    v_mov_b32 v109, v108
    buffer_load_ushort v124, v109, s[24:27], s58 offen
    v_add_u32 v109, 4096, v108
    buffer_load_ushort v125, v109, s[24:27], s58 offen
    v_add_u32 v109, 8192, v108
    buffer_load_ushort v126, v109, s[24:27], s58 offen
    v_add_u32 v109, 12288, v108
    buffer_load_ushort v127, v109, s[24:27], s58 offen
    s_barrier
    s_lshl_b32 s45, s43, 14
    v_lshl_add_u32 v103, v102, 4, s45
    ds_write_b128 v103, v[0:3] offset:0
    ds_write_b128 v103, v[4:7] offset:1024
    ds_write_b128 v103, v[8:11] offset:2048
    ds_write_b128 v103, v[12:15] offset:3072
    ds_write_b128 v103, v[16:19] offset:4096
    ds_write_b128 v103, v[20:23] offset:5120
    ds_write_b128 v103, v[24:27] offset:6144
    ds_write_b128 v103, v[28:31] offset:7168
    ds_write_b128 v103, v[32:35] offset:8192
    ds_write_b128 v103, v[36:39] offset:9216
    ds_write_b128 v103, v[40:43] offset:10240
    ds_write_b128 v103, v[44:47] offset:11264
    ds_write_b128 v103, v[48:51] offset:12288
    ds_write_b128 v103, v[52:55] offset:13312
    ds_write_b128 v103, v[56:59] offset:14336
    ds_write_b128 v103, v[60:63] offset:15360
    s_waitcnt lgkmcnt(0)
    s_barrier
    s_lshl_b32 s45, s43, 12
    v_lshl_add_u32 v103, v102, 4, s45
    ds_read_b128 v[0:3], v103 offset:0
    ds_read_b128 v[4:7], v103 offset:1024
    ds_read_b128 v[8:11], v103 offset:2048
    ds_read_b128 v[12:15], v103 offset:3072
    ds_read_b128 v[16:19], v103 offset:16384
    ds_read_b128 v[20:23], v103 offset:17408
    ds_read_b128 v[24:27], v103 offset:18432
    ds_read_b128 v[28:31], v103 offset:19456
    ds_read_b128 v[32:35], v103 offset:32768
    ds_read_b128 v[36:39], v103 offset:33792
    ds_read_b128 v[40:43], v103 offset:34816
    ds_read_b128 v[44:47], v103 offset:35840
    ds_read_b128 v[48:51], v103 offset:49152
    ds_read_b128 v[52:55], v103 offset:50176
    ds_read_b128 v[56:59], v103 offset:51200
    ds_read_b128 v[60:63], v103 offset:52224
    s_waitcnt lgkmcnt(0)
    v_add_f32 v0, v0, v16
    v_add_f32 v32, v32, v48
    v_add_f32 v0, v0, v32
    v_add_f32 v1, v1, v17
    v_add_f32 v33, v33, v49
    v_add_f32 v1, v1, v33
    v_add_f32 v2, v2, v18
    v_add_f32 v34, v34, v50
    v_add_f32 v2, v2, v34
    v_add_f32 v3, v3, v19
    v_add_f32 v35, v35, v51
    v_add_f32 v3, v3, v35
    v_add_f32 v4, v4, v20
    v_add_f32 v36, v36, v52
    v_add_f32 v4, v4, v36
    v_add_f32 v5, v5, v21
    v_add_f32 v37, v37, v53
    v_add_f32 v5, v5, v37
    v_add_f32 v6, v6, v22
    v_add_f32 v38, v38, v54
    v_add_f32 v6, v6, v38
    v_add_f32 v7, v7, v23
    v_add_f32 v39, v39, v55
    v_add_f32 v7, v7, v39
    v_add_f32 v8, v8, v24
    v_add_f32 v40, v40, v56
    v_add_f32 v8, v8, v40
    v_add_f32 v9, v9, v25
    v_add_f32 v41, v41, v57
    v_add_f32 v9, v9, v41
    v_add_f32 v10, v10, v26
    v_add_f32 v42, v42, v58
    v_add_f32 v10, v10, v42
    v_add_f32 v11, v11, v27
    v_add_f32 v43, v43, v59
    v_add_f32 v11, v11, v43
    v_add_f32 v12, v12, v28
    v_add_f32 v44, v44, v60
    v_add_f32 v12, v12, v44
    v_add_f32 v13, v13, v29
    v_add_f32 v45, v45, v61
    v_add_f32 v13, v13, v45
    v_add_f32 v14, v14, v30
    v_add_f32 v46, v46, v62
    v_add_f32 v14, v14, v46
    v_add_f32 v15, v15, v31
    v_add_f32 v47, v47, v63
    v_add_f32 v15, v15, v47
    s_waitcnt vmcnt(0)
    v_lshlrev_b32 v106, 16, v106
    v_cvt_pk_bf16_f32 v16, v0, v1
    v_lshlrev_b32 v0, 16, v16
    v_and_b32 v1, 0xffff0000, v16
    v_add_f32 v0, v0, v106
    v_add_f32 v1, v1, v106
    v_cvt_pk_bf16_f32 v16, v0, v1
    v_lshlrev_b32 v0, 16, v16
    v_and_b32 v1, 0xffff0000, v16
    v_lshlrev_b32 v17, 16, v80
    v_and_b32 v18, 0xffff0000, v80
    v_lshlrev_b32 v19, 16, v64
    v_and_b32 v20, 0xffff0000, v64
    v_mul_f32 v17, v17, v19
    v_mul_f32 v18, v18, v20
    v_cvt_pk_bf16_f32 v16, v17, v18
    v_lshlrev_b32 v17, 16, v16
    v_and_b32 v18, 0xffff0000, v16
    v_lshlrev_b32 v19, 16, v112
    v_lshlrev_b32 v20, 16, v113
    v_add_f32 v17, v17, v19
    v_add_f32 v18, v18, v20
    v_cvt_pk_bf16_f32 v16, v17, v18
    v_lshlrev_b32 v17, 16, v16
    v_and_b32 v18, 0xffff0000, v16
    v_lshlrev_b32 v19, 16, v72
    v_and_b32 v20, 0xffff0000, v72
    v_add_f32 v17, v17, v19
    v_add_f32 v18, v18, v20
    v_cvt_pk_bf16_f32 v16, v17, v18
    v_lshlrev_b32 v17, 16, v16
    v_and_b32 v18, 0xffff0000, v16
    v_add_f32 v17, v17, v0
    v_add_f32 v18, v18, v1
    v_cvt_pk_bf16_f32 v24, v17, v18
    v_cvt_pk_bf16_f32 v16, v2, v3
    v_lshlrev_b32 v2, 16, v16
    v_and_b32 v3, 0xffff0000, v16
    v_add_f32 v2, v2, v106
    v_add_f32 v3, v3, v106
    v_cvt_pk_bf16_f32 v16, v2, v3
    v_lshlrev_b32 v2, 16, v16
    v_and_b32 v3, 0xffff0000, v16
    v_lshlrev_b32 v17, 16, v81
    v_and_b32 v18, 0xffff0000, v81
    v_lshlrev_b32 v19, 16, v65
    v_and_b32 v20, 0xffff0000, v65
    v_mul_f32 v17, v17, v19
    v_mul_f32 v18, v18, v20
    v_cvt_pk_bf16_f32 v16, v17, v18
    v_lshlrev_b32 v17, 16, v16
    v_and_b32 v18, 0xffff0000, v16
    v_lshlrev_b32 v19, 16, v114
    v_lshlrev_b32 v20, 16, v115
    v_add_f32 v17, v17, v19
    v_add_f32 v18, v18, v20
    v_cvt_pk_bf16_f32 v16, v17, v18
    v_lshlrev_b32 v17, 16, v16
    v_and_b32 v18, 0xffff0000, v16
    v_lshlrev_b32 v19, 16, v73
    v_and_b32 v20, 0xffff0000, v73
    v_add_f32 v17, v17, v19
    v_add_f32 v18, v18, v20
    v_cvt_pk_bf16_f32 v16, v17, v18
    v_lshlrev_b32 v17, 16, v16
    v_and_b32 v18, 0xffff0000, v16
    v_add_f32 v17, v17, v2
    v_add_f32 v18, v18, v3
    v_cvt_pk_bf16_f32 v25, v17, v18
    v_cvt_pk_bf16_f32 v16, v4, v5
    v_lshlrev_b32 v4, 16, v16
    v_and_b32 v5, 0xffff0000, v16
    v_add_f32 v4, v4, v106
    v_add_f32 v5, v5, v106
    v_cvt_pk_bf16_f32 v16, v4, v5
    v_lshlrev_b32 v4, 16, v16
    v_and_b32 v5, 0xffff0000, v16
    v_lshlrev_b32 v17, 16, v82
    v_and_b32 v18, 0xffff0000, v82
    v_lshlrev_b32 v19, 16, v66
    v_and_b32 v20, 0xffff0000, v66
    v_mul_f32 v17, v17, v19
    v_mul_f32 v18, v18, v20
    v_cvt_pk_bf16_f32 v16, v17, v18
    v_lshlrev_b32 v17, 16, v16
    v_and_b32 v18, 0xffff0000, v16
    v_lshlrev_b32 v19, 16, v116
    v_lshlrev_b32 v20, 16, v117
    v_add_f32 v17, v17, v19
    v_add_f32 v18, v18, v20
    v_cvt_pk_bf16_f32 v16, v17, v18
    v_lshlrev_b32 v17, 16, v16
    v_and_b32 v18, 0xffff0000, v16
    v_lshlrev_b32 v19, 16, v74
    v_and_b32 v20, 0xffff0000, v74
    v_add_f32 v17, v17, v19
    v_add_f32 v18, v18, v20
    v_cvt_pk_bf16_f32 v16, v17, v18
    v_lshlrev_b32 v17, 16, v16
    v_and_b32 v18, 0xffff0000, v16
    v_add_f32 v17, v17, v4
    v_add_f32 v18, v18, v5
    v_cvt_pk_bf16_f32 v26, v17, v18
    v_cvt_pk_bf16_f32 v16, v6, v7
    v_lshlrev_b32 v6, 16, v16
    v_and_b32 v7, 0xffff0000, v16
    v_add_f32 v6, v6, v106
    v_add_f32 v7, v7, v106
    v_cvt_pk_bf16_f32 v16, v6, v7
    v_lshlrev_b32 v6, 16, v16
    v_and_b32 v7, 0xffff0000, v16
    v_lshlrev_b32 v17, 16, v83
    v_and_b32 v18, 0xffff0000, v83
    v_lshlrev_b32 v19, 16, v67
    v_and_b32 v20, 0xffff0000, v67
    v_mul_f32 v17, v17, v19
    v_mul_f32 v18, v18, v20
    v_cvt_pk_bf16_f32 v16, v17, v18
    v_lshlrev_b32 v17, 16, v16
    v_and_b32 v18, 0xffff0000, v16
    v_lshlrev_b32 v19, 16, v118
    v_lshlrev_b32 v20, 16, v119
    v_add_f32 v17, v17, v19
    v_add_f32 v18, v18, v20
    v_cvt_pk_bf16_f32 v16, v17, v18
    v_lshlrev_b32 v17, 16, v16
    v_and_b32 v18, 0xffff0000, v16
    v_lshlrev_b32 v19, 16, v75
    v_and_b32 v20, 0xffff0000, v75
    v_add_f32 v17, v17, v19
    v_add_f32 v18, v18, v20
    v_cvt_pk_bf16_f32 v16, v17, v18
    v_lshlrev_b32 v17, 16, v16
    v_and_b32 v18, 0xffff0000, v16
    v_add_f32 v17, v17, v6
    v_add_f32 v18, v18, v7
    v_cvt_pk_bf16_f32 v27, v17, v18
    v_cvt_pk_bf16_f32 v16, v8, v9
    v_lshlrev_b32 v8, 16, v16
    v_and_b32 v9, 0xffff0000, v16
    v_add_f32 v8, v8, v106
    v_add_f32 v9, v9, v106
    v_cvt_pk_bf16_f32 v16, v8, v9
    v_lshlrev_b32 v8, 16, v16
    v_and_b32 v9, 0xffff0000, v16
    v_lshlrev_b32 v17, 16, v84
    v_and_b32 v18, 0xffff0000, v84
    v_lshlrev_b32 v19, 16, v68
    v_and_b32 v20, 0xffff0000, v68
    v_mul_f32 v17, v17, v19
    v_mul_f32 v18, v18, v20
    v_cvt_pk_bf16_f32 v16, v17, v18
    v_lshlrev_b32 v17, 16, v16
    v_and_b32 v18, 0xffff0000, v16
    v_lshlrev_b32 v19, 16, v120
    v_lshlrev_b32 v20, 16, v121
    v_add_f32 v17, v17, v19
    v_add_f32 v18, v18, v20
    v_cvt_pk_bf16_f32 v16, v17, v18
    v_lshlrev_b32 v17, 16, v16
    v_and_b32 v18, 0xffff0000, v16
    v_lshlrev_b32 v19, 16, v76
    v_and_b32 v20, 0xffff0000, v76
    v_add_f32 v17, v17, v19
    v_add_f32 v18, v18, v20
    v_cvt_pk_bf16_f32 v16, v17, v18
    v_lshlrev_b32 v17, 16, v16
    v_and_b32 v18, 0xffff0000, v16
    v_add_f32 v17, v17, v8
    v_add_f32 v18, v18, v9
    v_cvt_pk_bf16_f32 v28, v17, v18
    v_cvt_pk_bf16_f32 v16, v10, v11
    v_lshlrev_b32 v10, 16, v16
    v_and_b32 v11, 0xffff0000, v16
    v_add_f32 v10, v10, v106
    v_add_f32 v11, v11, v106
    v_cvt_pk_bf16_f32 v16, v10, v11
    v_lshlrev_b32 v10, 16, v16
    v_and_b32 v11, 0xffff0000, v16
    v_lshlrev_b32 v17, 16, v85
    v_and_b32 v18, 0xffff0000, v85
    v_lshlrev_b32 v19, 16, v69
    v_and_b32 v20, 0xffff0000, v69
    v_mul_f32 v17, v17, v19
    v_mul_f32 v18, v18, v20
    v_cvt_pk_bf16_f32 v16, v17, v18
    v_lshlrev_b32 v17, 16, v16
    v_and_b32 v18, 0xffff0000, v16
    v_lshlrev_b32 v19, 16, v122
    v_lshlrev_b32 v20, 16, v123
    v_add_f32 v17, v17, v19
    v_add_f32 v18, v18, v20
    v_cvt_pk_bf16_f32 v16, v17, v18
    v_lshlrev_b32 v17, 16, v16
    v_and_b32 v18, 0xffff0000, v16
    v_lshlrev_b32 v19, 16, v77
    v_and_b32 v20, 0xffff0000, v77
    v_add_f32 v17, v17, v19
    v_add_f32 v18, v18, v20
    v_cvt_pk_bf16_f32 v16, v17, v18
    v_lshlrev_b32 v17, 16, v16
    v_and_b32 v18, 0xffff0000, v16
    v_add_f32 v17, v17, v10
    v_add_f32 v18, v18, v11
    v_cvt_pk_bf16_f32 v29, v17, v18
    v_cvt_pk_bf16_f32 v16, v12, v13
    v_lshlrev_b32 v12, 16, v16
    v_and_b32 v13, 0xffff0000, v16
    v_add_f32 v12, v12, v106
    v_add_f32 v13, v13, v106
    v_cvt_pk_bf16_f32 v16, v12, v13
    v_lshlrev_b32 v12, 16, v16
    v_and_b32 v13, 0xffff0000, v16
    v_lshlrev_b32 v17, 16, v86
    v_and_b32 v18, 0xffff0000, v86
    v_lshlrev_b32 v19, 16, v70
    v_and_b32 v20, 0xffff0000, v70
    v_mul_f32 v17, v17, v19
    v_mul_f32 v18, v18, v20
    v_cvt_pk_bf16_f32 v16, v17, v18
    v_lshlrev_b32 v17, 16, v16
    v_and_b32 v18, 0xffff0000, v16
    v_lshlrev_b32 v19, 16, v124
    v_lshlrev_b32 v20, 16, v125
    v_add_f32 v17, v17, v19
    v_add_f32 v18, v18, v20
    v_cvt_pk_bf16_f32 v16, v17, v18
    v_lshlrev_b32 v17, 16, v16
    v_and_b32 v18, 0xffff0000, v16
    v_lshlrev_b32 v19, 16, v78
    v_and_b32 v20, 0xffff0000, v78
    v_add_f32 v17, v17, v19
    v_add_f32 v18, v18, v20
    v_cvt_pk_bf16_f32 v16, v17, v18
    v_lshlrev_b32 v17, 16, v16
    v_and_b32 v18, 0xffff0000, v16
    v_add_f32 v17, v17, v12
    v_add_f32 v18, v18, v13
    v_cvt_pk_bf16_f32 v30, v17, v18
    v_cvt_pk_bf16_f32 v16, v14, v15
    v_lshlrev_b32 v14, 16, v16
    v_and_b32 v15, 0xffff0000, v16
    v_add_f32 v14, v14, v106
    v_add_f32 v15, v15, v106
    v_cvt_pk_bf16_f32 v16, v14, v15
    v_lshlrev_b32 v14, 16, v16
    v_and_b32 v15, 0xffff0000, v16
    v_lshlrev_b32 v17, 16, v87
    v_and_b32 v18, 0xffff0000, v87
    v_lshlrev_b32 v19, 16, v71
    v_and_b32 v20, 0xffff0000, v71
    v_mul_f32 v17, v17, v19
    v_mul_f32 v18, v18, v20
    v_cvt_pk_bf16_f32 v16, v17, v18
    v_lshlrev_b32 v17, 16, v16
    v_and_b32 v18, 0xffff0000, v16
    v_lshlrev_b32 v19, 16, v126
    v_lshlrev_b32 v20, 16, v127
    v_add_f32 v17, v17, v19
    v_add_f32 v18, v18, v20
    v_cvt_pk_bf16_f32 v16, v17, v18
    v_lshlrev_b32 v17, 16, v16
    v_and_b32 v18, 0xffff0000, v16
    v_lshlrev_b32 v19, 16, v79
    v_and_b32 v20, 0xffff0000, v79
    v_add_f32 v17, v17, v19
    v_add_f32 v18, v18, v20
    v_cvt_pk_bf16_f32 v16, v17, v18
    v_lshlrev_b32 v17, 16, v16
    v_and_b32 v18, 0xffff0000, v16
    v_add_f32 v17, v17, v14
    v_add_f32 v18, v18, v15
    v_cvt_pk_bf16_f32 v31, v17, v18
    buffer_store_dwordx2 v[24:25], v105, s[36:39], s52 offen offset:0
    buffer_store_dwordx2 v[26:27], v105, s[36:39], s52 offen offset:16
    buffer_store_dwordx2 v[28:29], v105, s[36:39], s52 offen offset:32
    buffer_store_dwordx2 v[30:31], v105, s[36:39], s52 offen offset:48
K3_END:
    s_endpgm
.section .rodata,"a"
.p2align 6
.amdhsa_kernel k3_out_kernel
  .amdhsa_next_free_vgpr 128
  .amdhsa_next_free_sgpr 102
  .amdhsa_accum_offset 128
  .amdhsa_group_segment_fixed_size 0
  .amdhsa_kernarg_size 120
  .amdhsa_user_sgpr_count 2
  .amdhsa_user_sgpr_kernarg_segment_ptr 1
  .amdhsa_system_sgpr_workgroup_id_x 1
.end_amdhsa_kernel
.text
```
